```python
import torch

def _softmax(x, axis=-1):
    return torch.softmax(x, dim=axis)
def _gelu(x):
    return torch.nn.functional.gelu(x, approximate="tanh")
def _silu(x):
    return torch.nn.functional.silu(x)
def _sigmoid(x):
    return torch.sigmoid(x)
def _layernorm(x, axis=-1, eps=1e-5):
    m = x.mean(dim=axis, keepdim=True)
    v = x.var(dim=axis, keepdim=True, unbiased=False)
    return (x - m) / torch.sqrt(v + eps)
def _scatter_add(tgt, idx, src, axis=0):
    return tgt.clone().index_add_(axis, idx, src)
def _segment_sum(src, seg, n):
    out = torch.zeros((n,) + src.shape[1:], dtype=src.dtype)
    return out.index_add_(0, seg, src)
def _pad(x, pw):
    flat = tuple(v for pair in reversed(pw) for v in pair)
    return torch.nn.functional.pad(x, flat)

kernel_name = 'parallel_sum__mha_block_cached__glu_gated_bilinear__decode'

def setup_inputs():

    _w = (lambda a: (lambda t: t.to(torch.bfloat16) if t.is_floating_point() else t)(torch.as_tensor(a)))
    def _A_setup():
        B, Sq, D = 1, 1, 640
        H, Sk, Dh = 32, 32768, 192
        return {
            "x": _w((lambda *s: torch.randn(*s, dtype=torch.bfloat16) * 0.05)(B, Sq, D)),
            "k_cache": _w((lambda *s: torch.randn(*s, dtype=torch.bfloat16) * 3.2)(B, H, Sk, Dh)),
            "v_cache": _w((lambda *s: torch.randn(*s, dtype=torch.bfloat16) * 1.6)(B, H, Sk, Dh)),
            "wq": _w((lambda *s: torch.randn(*s, dtype=torch.bfloat16) * 3.2)(D, H * Dh) * (D ** -0.5)),
            "wo": _w((lambda *s: torch.randn(*s, dtype=torch.bfloat16) * 1.6)(H * Dh, D) * ((H * Dh) ** -0.5)),
        }
    _A_in = _A_setup()

    def _B_setup():
        B, S, D, F = 1, 1, 640, 1536
        return {
            "x": _w((lambda *s: torch.randn(*s, dtype=torch.bfloat16) * 0.05)(B, S, D)),
            "w_gate": _w((lambda *s: torch.randn(*s, dtype=torch.bfloat16) * 1.6)(D, F) * (D ** -0.5)),
            "w_up": _w((lambda *s: torch.randn(*s, dtype=torch.bfloat16) * 1.6)(D, F) * (D ** -0.5)),
            "w_down": _w((lambda *s: torch.randn(*s, dtype=torch.bfloat16) * 1.6)(F, D) * (F ** -0.5)),
        }
    _B_in = _B_setup()

    return {
        "A_x": _A_in["x"],
        "A_k_cache": _A_in["k_cache"],
        "A_v_cache": _A_in["v_cache"],
        "A_wq": _A_in["wq"],
        "A_wo": _A_in["wo"],
        "B_x": _B_in["x"],
        "B_w_gate": _B_in["w_gate"],
        "B_w_up": _B_in["w_up"],
        "B_w_down": _B_in["w_down"],
    }

def reference(A_x, A_k_cache, A_v_cache, A_wq, A_wo, B_x, B_w_gate, B_w_up, B_w_down):
    def _A_ref(x, k_cache, v_cache, wq, wo):
        B, Sq, D = x.shape
        H, Dh = 32, 192
        q = (lambda x, *d: x.permute(*d))((x @ wq).reshape(B, Sq, H, Dh), 0, 2, 1, 3)
        scores = torch.einsum("bhqd,bhkd->bhqk", q, k_cache) * (Dh ** -0.5)
        p = _softmax(scores, axis=-1)
        o = torch.einsum("bhqk,bhkd->bhqd", p, v_cache)
        return (lambda x, *d: x.permute(*d))(o, 0, 2, 1, 3).reshape(B, Sq, H * Dh) @ wo

    def _B_ref(x, w_gate, w_up, w_down):
        g = torch.einsum("bsd,df->bsf", x, w_gate)
        u = torch.einsum("bsd,df->bsf", x, w_up)
        h = g * u
        return torch.einsum("bsf,fd->bsd", h, w_down)

    x = A_x
    xn = _layernorm(x, axis=-1)
    return x + _A_ref(xn, A_k_cache, A_v_cache, A_wq, A_wo) + _B_ref(xn, B_w_gate, B_w_up, B_w_down)
```

```asm
; @launch grid=(256,1,1) block=(512,1,1) lds=120896
.amdgcn_target "amdgcn-amd-amdhsa--gfx950"
.text
.globl parallel_sum__mha_block_cached__glu_gated_bilinear__decode_kernel
.p2align 8
.type parallel_sum__mha_block_cached__glu_gated_bilinear__decode_kernel,@function
parallel_sum__mha_block_cached__glu_gated_bilinear__decode_kernel:
  s_cmp_ge_u32 s2, 256
  s_cbranch_scc1 L_end
  s_load_dwordx4 s[4:7], s[0:1], 0
  s_load_dwordx4 s[8:11], s[0:1], 16
  s_load_dwordx2 s[12:13], s[0:1], 32
  s_load_dwordx4 s[16:19], s[0:1], 48
  s_load_dwordx4 s[20:23], s[0:1], 64
  s_load_dwordx4 s[24:27], s[0:1], 80
  s_memrealtime s[70:71]
  v_lshrrev_b32 v1, 6, v0
  v_and_b32 v0, 63, v0
  v_readfirstlane_b32 s3, v1
  s_lshr_b32 s14, s2, 3
  s_and_b32 s15, s2, 7
  s_mov_b32 s100, s2
  s_mul_i32 s2, s15, 4
  s_add_u32 s14, s14, s2
  s_and_b32 s14, s14, 31
  s_lshl_b32 s2, s14, 3
  s_add_u32 s2, s2, s15
  s_add_u32 s15, s15, s14
  s_and_b32 s15, s15, 7
  s_lshl_b32 s2, s14, 3
  s_add_u32 s2, s2, s15
  s_cmp_ge_u32 s3, 4
  s_cbranch_scc1 L_S
  s_cmp_lg_u32 s3, 0
  s_cbranch_scc1 L_noz_1
  v_lshlrev_b32 v5, 2, v0
  v_mov_b32 v6, 0
  s_mov_b64 exec, 0xffff
  ds_write_b32 v5, v6 offset:4096
  s_mov_b64 exec, -1
L_noz_1:
  v_lshlrev_b32 v1, 2, v0
  v_lshlrev_b32 v2, 1, v0
  v_lshrrev_b32 v3, 3, v0
  v_and_b32 v4, 7, v0
  v_lshlrev_b32 v19, 5, v4
  v_lshl_add_u32 v19, v3, 2, v19
  v_mov_b32 v20, 1
  v_mov_b32 v21, 4096
  s_mov_b32 s60, 0xff00ff00
  s_mov_b32 s61, 0xff00ff00
  v_cmp_ne_u32 vcc, 0, v0
  v_mov_b32 v18, 0
  v_mov_b32 v8, 1073741824
  v_cndmask_b32 v18, v18, v8, vcc
  s_movk_i32 s63, 12288
  v_lshlrev_b32 v5, 4, v4
  v_mad_u32_u24 v16, v3, s63, v5
  s_lshl_b32 s67, s2, 11
  s_add_u32 s67, s67, 786432
  s_mov_b32 s90, s14
  s_lshr_b32 s62, s14, 1
  s_cmp_eq_u32 s62, 12
  s_cselect_b32 s91, 7, s15
  s_cmp_lg_u32 s15, 7
  s_cbranch_scc1 L_qown_2
  s_sub_u32 s62, s14, 0
  s_cmp_ge_u32 s62, 12
  s_cbranch_scc1 L_qown_2
  s_cmp_ge_u32 s62, 6
  s_cselect_b32 s90, 25, 24
  s_cselect_b32 s91, 6, 0
  s_sub_u32 s91, s62, s91
L_qown_2:
  s_cmp_ge_u32 s91, 3
  s_cselect_b32 s92, 1, 0
  s_mul_i32 s63, s92, 3
  s_sub_u32 s93, s91, s63
  s_lshl_b32 s94, s92, 2
  s_add_u32 s94, s94, s3
  s_mul_i32 s66, s94, 983040
  s_mul_i32 s94, s94, 160
  s_mul_i32 s63, s3, 320
  s_cmp_lt_u32 s91, 6
  s_cselect_b32 s94, s94, s63
  s_mul_i32 s63, s90, 384
  s_add_u32 s66, s66, s63
  s_lshl_b32 s63, s93, 7
  s_add_u32 s66, s66, s63
  s_waitcnt lgkmcnt(0)
  s_barrier
  s_mov_b32 s28, s4
  s_mov_b32 s29, s5
  s_mov_b32 s30, 1280
  s_mov_b32 s31, 0x20000
  s_mov_b32 s36, s26
  s_mov_b32 s37, s27
  s_mov_b32 s38, 2359296
  s_mov_b32 s39, 0x20000
  s_cmp_lt_u32 s91, 6
  s_cselect_b32 s63, 7864320, 0
  s_mov_b32 s32, s10
  s_mov_b32 s33, s11
  s_mov_b32 s34, s63
  s_mov_b32 s35, 0x20000
  buffer_load_dword v9, v1, s[28:31], 0 offen offset:0
  buffer_load_dword v10, v1, s[28:31], 0 offen offset:256
  buffer_load_dword v11, v1, s[28:31], 0 offen offset:512
  buffer_load_dword v12, v1, s[28:31], 0 offen offset:768
  buffer_load_dword v13, v1, s[28:31], 0 offen offset:1024
  buffer_load_ushort v14, v2, s[28:31], s94 offen offset:0
  buffer_load_ushort v15, v2, s[28:31], s94 offen offset:128
  buffer_load_ushort v17, v2, s[28:31], s94 offen offset:256
  s_cmp_ge_u32 s91, 6
  s_cbranch_scc1 L_noqload_3
  buffer_load_dwordx4 v[76:79], v16, s[32:35], s66 offen nt
  s_add_u32 s66, s66, 98304
  buffer_load_dwordx4 v[80:83], v16, s[32:35], s66 offen nt
  s_add_u32 s66, s66, 98304
  buffer_load_dwordx4 v[84:87], v16, s[32:35], s66 offen nt
  s_add_u32 s66, s66, 98304
  buffer_load_dwordx4 v[88:91], v16, s[32:35], s66 offen nt
  s_add_u32 s66, s66, 98304
  buffer_load_dwordx4 v[92:95], v16, s[32:35], s66 offen nt
  s_add_u32 s66, s66, 98304
  buffer_load_dwordx4 v[96:99], v16, s[32:35], s66 offen nt
  s_add_u32 s66, s66, 98304
  buffer_load_dwordx4 v[100:103], v16, s[32:35], s66 offen nt
  s_add_u32 s66, s66, 98304
  buffer_load_dwordx4 v[104:107], v16, s[32:35], s66 offen nt
  s_add_u32 s66, s66, 98304
  buffer_load_dwordx4 v[108:111], v16, s[32:35], s66 offen nt
  s_add_u32 s66, s66, 98304
  buffer_load_dwordx4 v[112:115], v16, s[32:35], s66 offen nt
  s_branch L_qloaded_4
L_noqload_3:
  s_mov_b64 exec, 1
  ds_add_u32 v21, v20 offset:16
  s_mov_b64 exec, -1
  s_waitcnt vmcnt(0)
L_qloaded_4:
  s_mov_b32 s44, s24
  s_mov_b32 s45, s25
  s_mov_b32 s46, 256
  s_mov_b32 s47, 0x20000
  s_cmp_lg_u32 s3, 0
  s_cbranch_scc1 L_noring_5
  v_mov_b32 v24, -1
  v_mov_b32 v25, -1
  v_mov_b32 v26, -1
  v_mov_b32 v27, -1
  v_lshlrev_b32 v28, 4, v0
  ds_write_b128 v28, v[24:27] offset:8256
  ds_write_b128 v28, v[24:27] offset:9280
  ds_write_b128 v28, v[24:27] offset:10304
  ds_write_b128 v28, v[24:27] offset:11328
  s_waitcnt lgkmcnt(0)
L_noring_5:
  s_waitcnt vmcnt(10)
  v_lshlrev_b32 v22, 16, v9
  v_and_b32 v23, 0xffff0000, v9
  v_lshlrev_b32 v24, 16, v10
  v_and_b32 v25, 0xffff0000, v10
  v_lshlrev_b32 v26, 16, v11
  v_and_b32 v27, 0xffff0000, v11
  v_lshlrev_b32 v28, 16, v12
  v_and_b32 v29, 0xffff0000, v12
  v_lshlrev_b32 v30, 16, v13
  v_and_b32 v31, 0xffff0000, v13
  v_add_f32 v5, v22, v23
  v_add_f32 v5, v5, v24
  v_add_f32 v5, v5, v25
  v_add_f32 v5, v5, v26
  v_add_f32 v5, v5, v27
  v_add_f32 v5, v5, v28
  v_add_f32 v5, v5, v29
  v_add_f32 v5, v5, v30
  v_add_f32 v5, v5, v31
  s_nop 1
  v_add_f32_dpp v5, v5, v5 quad_perm:[1,0,3,2] row_mask:0xf bank_mask:0xf
  s_nop 1
  v_add_f32_dpp v5, v5, v5 quad_perm:[2,3,0,1] row_mask:0xf bank_mask:0xf
  s_nop 1
  v_add_f32_dpp v5, v5, v5 row_half_mirror row_mask:0xf bank_mask:0xf
  s_nop 1
  v_add_f32_dpp v5, v5, v5 row_mirror row_mask:0xf bank_mask:0xf
  v_mov_b32 v6, v5
  s_nop 1
  v_permlane16_swap_b32 v5, v6
  v_add_f32 v5, v5, v6
  v_mov_b32 v6, v5
  s_nop 1
  v_permlane32_swap_b32 v5, v6
  v_add_f32 v5, v5, v6
  v_mul_f32 v5, 0x3acccccd, v5
  v_sub_f32 v22, v22, v5
  v_sub_f32 v23, v23, v5
  v_sub_f32 v24, v24, v5
  v_sub_f32 v25, v25, v5
  v_sub_f32 v26, v26, v5
  v_sub_f32 v27, v27, v5
  v_sub_f32 v28, v28, v5
  v_sub_f32 v29, v29, v5
  v_sub_f32 v30, v30, v5
  v_sub_f32 v31, v31, v5
  v_mul_f32 v7, v22, v22
  v_fmac_f32 v7, v23, v23
  v_fmac_f32 v7, v24, v24
  v_fmac_f32 v7, v25, v25
  v_fmac_f32 v7, v26, v26
  v_fmac_f32 v7, v27, v27
  v_fmac_f32 v7, v28, v28
  v_fmac_f32 v7, v29, v29
  v_fmac_f32 v7, v30, v30
  v_fmac_f32 v7, v31, v31
  s_nop 1
  v_add_f32_dpp v7, v7, v7 quad_perm:[1,0,3,2] row_mask:0xf bank_mask:0xf
  s_nop 1
  v_add_f32_dpp v7, v7, v7 quad_perm:[2,3,0,1] row_mask:0xf bank_mask:0xf
  s_nop 1
  v_add_f32_dpp v7, v7, v7 row_half_mirror row_mask:0xf bank_mask:0xf
  s_nop 1
  v_add_f32_dpp v7, v7, v7 row_mirror row_mask:0xf bank_mask:0xf
  v_mov_b32 v6, v7
  s_nop 1
  v_permlane16_swap_b32 v7, v6
  v_add_f32 v7, v7, v6
  v_mov_b32 v6, v7
  s_nop 1
  v_permlane32_swap_b32 v7, v6
  v_add_f32 v7, v7, v6
  v_mul_f32 v7, 0x3acccccd, v7
  v_cvt_pk_bf16_f32 v5, 0, v5
  v_cvt_pk_bf16_f32 v7, 0, v7
  v_add_f32 v7, 0x3727c5ac, v7
  v_cvt_pk_bf16_f32 v7, 0, v7
  v_sqrt_f32 v7, v7
  s_nop 0
  v_cvt_pk_bf16_f32 v7, 0, v7
  v_rcp_f32 v8, v7
  v_lshlrev_b32 v14, 16, v14
  v_sub_f32 v14, v14, v5
  v_cvt_pk_bf16_f32 v14, 0, v14
  v_mul_f32 v6, v14, v8
  v_fma_f32 v14, -v6, v7, v14
  v_fma_f32 v14, v14, v8, v6
  v_cvt_pk_bf16_f32 v14, v14, 0
  v_lshlrev_b32 v15, 16, v15
  v_sub_f32 v15, v15, v5
  v_cvt_pk_bf16_f32 v15, 0, v15
  v_mul_f32 v6, v15, v8
  v_fma_f32 v15, -v6, v7, v15
  v_fma_f32 v15, v15, v8, v6
  v_cvt_pk_bf16_f32 v15, v15, 0
  v_lshlrev_b32 v17, 16, v17
  v_sub_f32 v17, v17, v5
  v_cvt_pk_bf16_f32 v17, 0, v17
  v_mul_f32 v6, v17, v8
  v_fma_f32 v17, -v6, v7, v17
  v_fma_f32 v17, v17, v8, v6
  v_cvt_pk_bf16_f32 v17, v17, 0
  v_lshlrev_b32 v5, 2, v3
  ds_bpermute_b32 v32, v5, v14 offset:0
  ds_bpermute_b32 v33, v5, v14 offset:32
  ds_bpermute_b32 v34, v5, v14 offset:64
  ds_bpermute_b32 v35, v5, v14 offset:96
  ds_bpermute_b32 v36, v5, v14 offset:128
  ds_bpermute_b32 v37, v5, v14 offset:160
  ds_bpermute_b32 v38, v5, v14 offset:192
  ds_bpermute_b32 v39, v5, v14 offset:224
  ds_bpermute_b32 v40, v5, v15 offset:0
  ds_bpermute_b32 v41, v5, v15 offset:32
  ds_bpermute_b32 v42, v5, v15 offset:64
  ds_bpermute_b32 v43, v5, v15 offset:96
  ds_bpermute_b32 v44, v5, v15 offset:128
  ds_bpermute_b32 v45, v5, v15 offset:160
  ds_bpermute_b32 v46, v5, v15 offset:192
  ds_bpermute_b32 v47, v5, v15 offset:224
  ds_bpermute_b32 v48, v5, v17 offset:0
  ds_bpermute_b32 v49, v5, v17 offset:32
  ds_bpermute_b32 v50, v5, v17 offset:64
  ds_bpermute_b32 v51, v5, v17 offset:96
  s_waitcnt lgkmcnt(0)
  s_cmp_lg_u32 s3, 0
  s_cbranch_scc1 L_n0_6
  buffer_load_dword v75, off, s[44:47], 0 sc1
  s_branch L_n1_7
L_n0_6:
  buffer_load_dword v75, off, s[28:31], 0
L_n1_7:
  s_cmp_ge_u32 s91, 6
  s_cbranch_scc1 L_noq_8
  v_mov_b32 v52, 0
  v_mov_b32 v53, 0
  v_mov_b32 v54, 0
  v_mov_b32 v55, 0
  v_mov_b32 v56, 0
  v_mov_b32 v57, 0
  v_mov_b32 v58, 0
  v_mov_b32 v59, 0
  v_lshlrev_b32 v9, 16, v32
  s_waitcnt vmcnt(10)
  v_dot2c_f32_bf16 v52, v76, v32
  v_dot2c_f32_bf16 v53, v76, v9
  v_dot2c_f32_bf16 v54, v77, v32
  v_dot2c_f32_bf16 v55, v77, v9
  v_dot2c_f32_bf16 v56, v78, v32
  v_dot2c_f32_bf16 v57, v78, v9
  v_dot2c_f32_bf16 v58, v79, v32
  v_dot2c_f32_bf16 v59, v79, v9
  v_lshlrev_b32 v10, 16, v33
  s_waitcnt vmcnt(9)
  v_dot2c_f32_bf16 v52, v80, v33
  v_dot2c_f32_bf16 v53, v80, v10
  v_dot2c_f32_bf16 v54, v81, v33
  v_dot2c_f32_bf16 v55, v81, v10
  v_dot2c_f32_bf16 v56, v82, v33
  v_dot2c_f32_bf16 v57, v82, v10
  v_dot2c_f32_bf16 v58, v83, v33
  v_dot2c_f32_bf16 v59, v83, v10
  v_lshlrev_b32 v9, 16, v34
  s_waitcnt vmcnt(8)
  v_dot2c_f32_bf16 v52, v84, v34
  v_dot2c_f32_bf16 v53, v84, v9
  v_dot2c_f32_bf16 v54, v85, v34
  v_dot2c_f32_bf16 v55, v85, v9
  v_dot2c_f32_bf16 v56, v86, v34
  v_dot2c_f32_bf16 v57, v86, v9
  v_dot2c_f32_bf16 v58, v87, v34
  v_dot2c_f32_bf16 v59, v87, v9
  v_lshlrev_b32 v10, 16, v35
  s_waitcnt vmcnt(7)
  v_dot2c_f32_bf16 v52, v88, v35
  v_dot2c_f32_bf16 v53, v88, v10
  v_dot2c_f32_bf16 v54, v89, v35
  v_dot2c_f32_bf16 v55, v89, v10
  v_dot2c_f32_bf16 v56, v90, v35
  v_dot2c_f32_bf16 v57, v90, v10
  v_dot2c_f32_bf16 v58, v91, v35
  v_dot2c_f32_bf16 v59, v91, v10
  v_lshlrev_b32 v9, 16, v36
  s_waitcnt vmcnt(6)
  v_dot2c_f32_bf16 v52, v92, v36
  v_dot2c_f32_bf16 v53, v92, v9
  v_dot2c_f32_bf16 v54, v93, v36
  v_dot2c_f32_bf16 v55, v93, v9
  v_dot2c_f32_bf16 v56, v94, v36
  v_dot2c_f32_bf16 v57, v94, v9
  v_dot2c_f32_bf16 v58, v95, v36
  v_dot2c_f32_bf16 v59, v95, v9
  v_lshlrev_b32 v10, 16, v37
  s_waitcnt vmcnt(5)
  v_dot2c_f32_bf16 v52, v96, v37
  v_dot2c_f32_bf16 v53, v96, v10
  v_dot2c_f32_bf16 v54, v97, v37
  v_dot2c_f32_bf16 v55, v97, v10
  v_dot2c_f32_bf16 v56, v98, v37
  v_dot2c_f32_bf16 v57, v98, v10
  v_dot2c_f32_bf16 v58, v99, v37
  v_dot2c_f32_bf16 v59, v99, v10
  v_lshlrev_b32 v9, 16, v38
  s_waitcnt vmcnt(4)
  v_dot2c_f32_bf16 v52, v100, v38
  v_dot2c_f32_bf16 v53, v100, v9
  v_dot2c_f32_bf16 v54, v101, v38
  v_dot2c_f32_bf16 v55, v101, v9
  v_dot2c_f32_bf16 v56, v102, v38
  v_dot2c_f32_bf16 v57, v102, v9
  v_dot2c_f32_bf16 v58, v103, v38
  v_dot2c_f32_bf16 v59, v103, v9
  v_lshlrev_b32 v10, 16, v39
  s_waitcnt vmcnt(3)
  v_dot2c_f32_bf16 v52, v104, v39
  v_dot2c_f32_bf16 v53, v104, v10
  v_dot2c_f32_bf16 v54, v105, v39
  v_dot2c_f32_bf16 v55, v105, v10
  v_dot2c_f32_bf16 v56, v106, v39
  v_dot2c_f32_bf16 v57, v106, v10
  v_dot2c_f32_bf16 v58, v107, v39
  v_dot2c_f32_bf16 v59, v107, v10
  v_lshlrev_b32 v9, 16, v40
  s_waitcnt vmcnt(2)
  v_dot2c_f32_bf16 v52, v108, v40
  v_dot2c_f32_bf16 v53, v108, v9
  v_dot2c_f32_bf16 v54, v109, v40
  v_dot2c_f32_bf16 v55, v109, v9
  v_dot2c_f32_bf16 v56, v110, v40
  v_dot2c_f32_bf16 v57, v110, v9
  v_dot2c_f32_bf16 v58, v111, v40
  v_dot2c_f32_bf16 v59, v111, v9
  v_lshlrev_b32 v10, 16, v41
  s_waitcnt vmcnt(1)
  v_dot2c_f32_bf16 v52, v112, v41
  v_dot2c_f32_bf16 v53, v112, v10
  v_dot2c_f32_bf16 v54, v113, v41
  v_dot2c_f32_bf16 v55, v113, v10
  v_dot2c_f32_bf16 v56, v114, v41
  v_dot2c_f32_bf16 v57, v114, v10
  v_dot2c_f32_bf16 v58, v115, v41
  v_dot2c_f32_bf16 v59, v115, v10
  s_mov_b64 exec, 1
  ds_add_u32 v21, v20 offset:16
  s_mov_b64 exec, -1
  v_permlane32_swap_b32 v52, v56
  v_permlane32_swap_b32 v53, v57
  v_permlane32_swap_b32 v54, v58
  v_permlane32_swap_b32 v55, v59
  v_add_f32 v52, v52, v56
  v_add_f32 v53, v53, v57
  v_add_f32 v54, v54, v58
  v_add_f32 v55, v55, v59
  s_nop 0
  v_permlane16_swap_b32 v52, v54
  v_permlane16_swap_b32 v53, v55
  v_add_f32 v52, v52, v54
  v_add_f32 v53, v53, v55
  s_nop 0
  v_add_f32_dpp v52, v52, v52 row_ror:8 row_mask:0xf bank_mask:0xf
  v_add_f32_dpp v53, v53, v53 row_ror:8 row_mask:0xf bank_mask:0xf
  v_cndmask_b32 v52, v52, v53, s[60:61]
  s_lshl_b32 s62, s3, 8
  v_add_u32 v6, s62, v19
  ds_write_b32 v6, v52 offset:0
  s_mov_b64 exec, 1
  ds_add_u32 v21, v20 offset:28
  s_mov_b64 exec, -1
L_noq_8:
  v_lshlrev_b32 v17, 3, v0
  s_cmp_lg_u32 s3, 0
  s_cbranch_scc1 L_Hn0_9
  s_mov_b32 s64, 65536
L_pollf_10:
  s_waitcnt vmcnt(0)
  v_readfirstlane_b32 s65, v75
  s_cmp_lg_u32 s65, 0
  s_cbranch_scc1 L_pollf_ok_11
  s_sub_u32 s64, s64, 1
  s_cbranch_scc1 L_pollf_ok_11
  s_sleep 2
  buffer_load_dword v75, off, s[44:47], 0 sc1
  s_branch L_pollf_10
L_pollf_ok_11:
  ds_write_b32 v21, v75 offset:12
  s_cmp_ge_u32 s91, 6
  s_cbranch_scc1 L_nopub_12
  s_mov_b32 s64, 262144
L_cw_13:
  ds_read_b32 v5, v21 offset:28
  s_waitcnt lgkmcnt(0)
  v_readfirstlane_b32 s62, v5
  s_cmp_ge_u32 s62, 4
  s_cbranch_scc1 L_cw_done_14
  s_sub_u32 s64, s64, 1
  s_cbranch_scc1 L_cw_done_14
  s_branch L_cw_13
L_cw_done_14:
  ds_read_b32 v52, v1 offset:0
  ds_read_b32 v53, v1 offset:256
  ds_read_b32 v54, v1 offset:512
  ds_read_b32 v55, v1 offset:768
  s_lshl_b32 s62, s90, 12
  s_lshl_b32 s63, s91, 9
  s_add_u32 s62, s62, s63
  s_add_u32 s62, s62, 131072
  s_waitcnt lgkmcnt(0)
  v_add_f32 v52, v52, v53
  v_add_f32 v54, v54, v55
  v_add_f32 v52, v52, v54
  v_mov_b32 v53, s65
  buffer_store_dwordx2 v[52:53], v17, s[36:39], s62 offen sc1
L_nopub_12:
  s_cmp_lg_u32 s15, 7
  s_cbranch_scc1 L_notick_15
  v_mov_b32 v6, 0
  v_mov_b32 v7, s65
  s_lshl_b32 s62, s14, 8
  s_add_u32 s62, s62, 0
  buffer_store_dwordx2 v[6:7], v18, s[36:39], s62 offen sc1
L_notick_15:
  v_lshlrev_b32 v72, 4, v0
  v_min_u32 v8, 31, v0
  v_lshlrev_b32 v73, 4, v8
  v_lshlrev_b32 v8, 2, v8
  s_lshl_b32 s62, s14, 12
  s_add_u32 s62, s62, 131072
  s_mov_b32 s64, 65536
L_gath_16:
  buffer_load_dwordx4 v[56:59], v72, s[36:39], s62 offen sc1
  buffer_load_dwordx4 v[60:63], v72, s[36:39], s62 offen offset:1536 sc1
  buffer_load_dwordx4 v[64:67], v73, s[36:39], s62 offen offset:1024 sc1
  buffer_load_dwordx4 v[68:71], v73, s[36:39], s62 offen offset:2560 sc1
  s_waitcnt vmcnt(0)
  v_max3_u32 v5, v57, v59, v61
  v_max3_u32 v5, v5, v63, v65
  v_max3_u32 v5, v5, v67, v69
  v_max_u32 v5, v5, v71
  v_min3_u32 v6, v57, v59, v61
  v_min3_u32 v6, v6, v63, v65
  v_min3_u32 v6, v6, v67, v69
  v_min_u32 v6, v6, v71
  v_xor_b32 v5, s65, v5
  v_xor_b32 v6, s65, v6
  v_or_b32 v5, v5, v6
  v_cmp_ne_u32 vcc, 0, v5
  s_cbranch_vccz L_gath_done_17
  s_sub_u32 s64, s64, 1
  s_cbranch_scc1 L_gath_done_17
  s_sleep 1
  s_branch L_gath_16
L_gath_done_17:
  v_add_f32 v56, v56, v60
  v_add_f32 v58, v58, v62
  v_cvt_pk_bf16_f32 v56, v56, v58
  v_add_f32 v64, v64, v68
  v_add_f32 v66, v66, v70
  v_cvt_pk_bf16_f32 v64, v64, v66
  ds_write_b32 v1, v56 offset:3328
  ds_write_b32 v8, v64 offset:3584
  s_mov_b64 exec, 1
  ds_add_u32 v21, v20 offset:4
  s_mov_b64 exec, -1
L_Hn0_9:
  s_mov_b32 s64, 262144
L_pollN_18:
  ds_read_b32 v5, v21 offset:12
  s_waitcnt lgkmcnt(0)
  v_readfirstlane_b32 s65, v5
  s_cmp_lg_u32 s65, 0
  s_cbranch_scc1 L_pollN_done_19
  s_sub_u32 s64, s64, 1
  s_cbranch_scc1 L_pollN_done_19
  s_sleep 1
  s_branch L_pollN_18
L_pollN_done_19:
  s_cmp_ge_u32 s14, 24
  s_cbranch_scc1 L_taskB_21
  s_cmp_lg_u32 s15, 6
  s_cbranch_scc1 L_Hjoin_22
  s_mov_b32 s64, 262144
L_cw_23:
  ds_read_b32 v5, v21 offset:4
  s_waitcnt lgkmcnt(0)
  v_readfirstlane_b32 s62, v5
  s_cmp_ge_u32 s62, 1
  s_cbranch_scc1 L_cw_done_24
  s_sub_u32 s64, s64, 1
  s_cbranch_scc1 L_cw_done_24
  s_sleep 2
  s_branch L_cw_23
L_cw_done_24:
  s_mov_b32 s32, s16
  s_mov_b32 s33, s17
  s_mov_b32 s34, 1966080
  s_mov_b32 s35, 0x20000
  s_mov_b32 s40, s18
  s_mov_b32 s41, s19
  s_mov_b32 s42, 1966080
  s_mov_b32 s43, 0x20000
  s_movk_i32 s63, 3072
  v_lshlrev_b32 v5, 4, v4
  v_mad_u32_u24 v16, v3, s63, v5
  s_mul_i32 s62, s3, 491520
  s_lshl_b32 s63, s14, 7
  s_add_u32 s62, s62, s63
  buffer_load_dwordx4 v[76:79], v16, s[32:35], s62 offen nt
  buffer_load_dwordx4 v[80:83], v16, s[40:43], s62 offen nt
  s_add_u32 s62, s62, 24576
  buffer_load_dwordx4 v[84:87], v16, s[32:35], s62 offen nt
  buffer_load_dwordx4 v[88:91], v16, s[40:43], s62 offen nt
  s_add_u32 s62, s62, 24576
  buffer_load_dwordx4 v[92:95], v16, s[32:35], s62 offen nt
  buffer_load_dwordx4 v[96:99], v16, s[40:43], s62 offen nt
  s_add_u32 s62, s62, 24576
  buffer_load_dwordx4 v[100:103], v16, s[32:35], s62 offen nt
  buffer_load_dwordx4 v[104:107], v16, s[40:43], s62 offen nt
  s_add_u32 s62, s62, 24576
  buffer_load_dwordx4 v[108:111], v16, s[32:35], s62 offen nt
  buffer_load_dwordx4 v[112:115], v16, s[40:43], s62 offen nt
  s_add_u32 s62, s62, 24576
  buffer_load_dwordx4 v[116:119], v16, s[32:35], s62 offen nt
  buffer_load_dwordx4 v[120:123], v16, s[40:43], s62 offen nt
  s_add_u32 s62, s62, 24576
  buffer_load_dwordx4 v[124:127], v16, s[32:35], s62 offen nt
  buffer_load_dwordx4 v[128:131], v16, s[40:43], s62 offen nt
  s_add_u32 s62, s62, 24576
  buffer_load_dwordx4 v[132:135], v16, s[32:35], s62 offen nt
  buffer_load_dwordx4 v[136:139], v16, s[40:43], s62 offen nt
  s_add_u32 s62, s62, 24576
  buffer_load_dwordx4 v[140:143], v16, s[32:35], s62 offen nt
  buffer_load_dwordx4 v[144:147], v16, s[40:43], s62 offen nt
  s_add_u32 s62, s62, 24576
  buffer_load_dwordx4 v[148:151], v16, s[32:35], s62 offen nt
  buffer_load_dwordx4 v[152:155], v16, s[40:43], s62 offen nt
  s_add_u32 s62, s62, 24576
  buffer_load_dwordx4 v[156:159], v16, s[32:35], s62 offen nt
  buffer_load_dwordx4 v[160:163], v16, s[40:43], s62 offen nt
  s_add_u32 s62, s62, 24576
  buffer_load_dwordx4 v[164:167], v16, s[32:35], s62 offen nt
  buffer_load_dwordx4 v[168:171], v16, s[40:43], s62 offen nt
  s_add_u32 s62, s62, 24576
  buffer_load_dwordx4 v[172:175], v16, s[32:35], s62 offen nt
  buffer_load_dwordx4 v[176:179], v16, s[40:43], s62 offen nt
  s_add_u32 s62, s62, 24576
  buffer_load_dwordx4 v[180:183], v16, s[32:35], s62 offen nt
  buffer_load_dwordx4 v[184:187], v16, s[40:43], s62 offen nt
  s_add_u32 s62, s62, 24576
  buffer_load_dwordx4 v[188:191], v16, s[32:35], s62 offen nt
  buffer_load_dwordx4 v[192:195], v16, s[40:43], s62 offen nt
  s_add_u32 s62, s62, 24576
  buffer_load_dwordx4 v[196:199], v16, s[32:35], s62 offen nt
  buffer_load_dwordx4 v[200:203], v16, s[40:43], s62 offen nt
  s_add_u32 s62, s62, 24576
  buffer_load_dwordx4 v[204:207], v16, s[32:35], s62 offen nt
  buffer_load_dwordx4 v[208:211], v16, s[40:43], s62 offen nt
  s_add_u32 s62, s62, 24576
  buffer_load_dwordx4 v[212:215], v16, s[32:35], s62 offen nt
  buffer_load_dwordx4 v[216:219], v16, s[40:43], s62 offen nt
  s_add_u32 s62, s62, 24576
  buffer_load_dwordx4 v[220:223], v16, s[32:35], s62 offen nt
  buffer_load_dwordx4 v[224:227], v16, s[40:43], s62 offen nt
  s_add_u32 s62, s62, 24576
  buffer_load_dwordx4 v[228:231], v16, s[32:35], s62 offen nt
  buffer_load_dwordx4 v[232:235], v16, s[40:43], s62 offen nt
  v_mov_b32 v52, 0
  v_mov_b32 v53, 0
  v_mov_b32 v54, 0
  v_mov_b32 v55, 0
  v_mov_b32 v56, 0
  v_mov_b32 v57, 0
  v_mov_b32 v58, 0
  v_mov_b32 v59, 0
  v_mov_b32 v60, 0
  v_mov_b32 v61, 0
  v_mov_b32 v62, 0
  v_mov_b32 v63, 0
  v_mov_b32 v64, 0
  v_mov_b32 v65, 0
  v_mov_b32 v66, 0
  v_mov_b32 v67, 0
  v_lshlrev_b32 v9, 16, v32
  s_waitcnt vmcnt(38)
  v_dot2c_f32_bf16 v52, v76, v32
  v_dot2c_f32_bf16 v53, v76, v9
  v_dot2c_f32_bf16 v54, v77, v32
  v_dot2c_f32_bf16 v55, v77, v9
  v_dot2c_f32_bf16 v56, v78, v32
  v_dot2c_f32_bf16 v57, v78, v9
  v_dot2c_f32_bf16 v58, v79, v32
  v_dot2c_f32_bf16 v59, v79, v9
  v_dot2c_f32_bf16 v60, v80, v32
  v_dot2c_f32_bf16 v61, v80, v9
  v_dot2c_f32_bf16 v62, v81, v32
  v_dot2c_f32_bf16 v63, v81, v9
  v_dot2c_f32_bf16 v64, v82, v32
  v_dot2c_f32_bf16 v65, v82, v9
  v_dot2c_f32_bf16 v66, v83, v32
  v_dot2c_f32_bf16 v67, v83, v9
  v_lshlrev_b32 v10, 16, v33
  s_waitcnt vmcnt(36)
  v_dot2c_f32_bf16 v52, v84, v33
  v_dot2c_f32_bf16 v53, v84, v10
  v_dot2c_f32_bf16 v54, v85, v33
  v_dot2c_f32_bf16 v55, v85, v10
  v_dot2c_f32_bf16 v56, v86, v33
  v_dot2c_f32_bf16 v57, v86, v10
  v_dot2c_f32_bf16 v58, v87, v33
  v_dot2c_f32_bf16 v59, v87, v10
  v_dot2c_f32_bf16 v60, v88, v33
  v_dot2c_f32_bf16 v61, v88, v10
  v_dot2c_f32_bf16 v62, v89, v33
  v_dot2c_f32_bf16 v63, v89, v10
  v_dot2c_f32_bf16 v64, v90, v33
  v_dot2c_f32_bf16 v65, v90, v10
  v_dot2c_f32_bf16 v66, v91, v33
  v_dot2c_f32_bf16 v67, v91, v10
  v_lshlrev_b32 v9, 16, v34
  s_waitcnt vmcnt(34)
  v_dot2c_f32_bf16 v52, v92, v34
  v_dot2c_f32_bf16 v53, v92, v9
  v_dot2c_f32_bf16 v54, v93, v34
  v_dot2c_f32_bf16 v55, v93, v9
  v_dot2c_f32_bf16 v56, v94, v34
  v_dot2c_f32_bf16 v57, v94, v9
  v_dot2c_f32_bf16 v58, v95, v34
  v_dot2c_f32_bf16 v59, v95, v9
  v_dot2c_f32_bf16 v60, v96, v34
  v_dot2c_f32_bf16 v61, v96, v9
  v_dot2c_f32_bf16 v62, v97, v34
  v_dot2c_f32_bf16 v63, v97, v9
  v_dot2c_f32_bf16 v64, v98, v34
  v_dot2c_f32_bf16 v65, v98, v9
  v_dot2c_f32_bf16 v66, v99, v34
  v_dot2c_f32_bf16 v67, v99, v9
  v_lshlrev_b32 v10, 16, v35
  s_waitcnt vmcnt(32)
  v_dot2c_f32_bf16 v52, v100, v35
  v_dot2c_f32_bf16 v53, v100, v10
  v_dot2c_f32_bf16 v54, v101, v35
  v_dot2c_f32_bf16 v55, v101, v10
  v_dot2c_f32_bf16 v56, v102, v35
  v_dot2c_f32_bf16 v57, v102, v10
  v_dot2c_f32_bf16 v58, v103, v35
  v_dot2c_f32_bf16 v59, v103, v10
  v_dot2c_f32_bf16 v60, v104, v35
  v_dot2c_f32_bf16 v61, v104, v10
  v_dot2c_f32_bf16 v62, v105, v35
  v_dot2c_f32_bf16 v63, v105, v10
  v_dot2c_f32_bf16 v64, v106, v35
  v_dot2c_f32_bf16 v65, v106, v10
  v_dot2c_f32_bf16 v66, v107, v35
  v_dot2c_f32_bf16 v67, v107, v10
  v_lshlrev_b32 v9, 16, v36
  s_waitcnt vmcnt(30)
  v_dot2c_f32_bf16 v52, v108, v36
  v_dot2c_f32_bf16 v53, v108, v9
  v_dot2c_f32_bf16 v54, v109, v36
  v_dot2c_f32_bf16 v55, v109, v9
  v_dot2c_f32_bf16 v56, v110, v36
  v_dot2c_f32_bf16 v57, v110, v9
  v_dot2c_f32_bf16 v58, v111, v36
  v_dot2c_f32_bf16 v59, v111, v9
  v_dot2c_f32_bf16 v60, v112, v36
  v_dot2c_f32_bf16 v61, v112, v9
  v_dot2c_f32_bf16 v62, v113, v36
  v_dot2c_f32_bf16 v63, v113, v9
  v_dot2c_f32_bf16 v64, v114, v36
  v_dot2c_f32_bf16 v65, v114, v9
  v_dot2c_f32_bf16 v66, v115, v36
  v_dot2c_f32_bf16 v67, v115, v9
  v_lshlrev_b32 v10, 16, v37
  s_waitcnt vmcnt(28)
  v_dot2c_f32_bf16 v52, v116, v37
  v_dot2c_f32_bf16 v53, v116, v10
  v_dot2c_f32_bf16 v54, v117, v37
  v_dot2c_f32_bf16 v55, v117, v10
  v_dot2c_f32_bf16 v56, v118, v37
  v_dot2c_f32_bf16 v57, v118, v10
  v_dot2c_f32_bf16 v58, v119, v37
  v_dot2c_f32_bf16 v59, v119, v10
  v_dot2c_f32_bf16 v60, v120, v37
  v_dot2c_f32_bf16 v61, v120, v10
  v_dot2c_f32_bf16 v62, v121, v37
  v_dot2c_f32_bf16 v63, v121, v10
  v_dot2c_f32_bf16 v64, v122, v37
  v_dot2c_f32_bf16 v65, v122, v10
  v_dot2c_f32_bf16 v66, v123, v37
  v_dot2c_f32_bf16 v67, v123, v10
  v_lshlrev_b32 v9, 16, v38
  s_waitcnt vmcnt(26)
  v_dot2c_f32_bf16 v52, v124, v38
  v_dot2c_f32_bf16 v53, v124, v9
  v_dot2c_f32_bf16 v54, v125, v38
  v_dot2c_f32_bf16 v55, v125, v9
  v_dot2c_f32_bf16 v56, v126, v38
  v_dot2c_f32_bf16 v57, v126, v9
  v_dot2c_f32_bf16 v58, v127, v38
  v_dot2c_f32_bf16 v59, v127, v9
  v_dot2c_f32_bf16 v60, v128, v38
  v_dot2c_f32_bf16 v61, v128, v9
  v_dot2c_f32_bf16 v62, v129, v38
  v_dot2c_f32_bf16 v63, v129, v9
  v_dot2c_f32_bf16 v64, v130, v38
  v_dot2c_f32_bf16 v65, v130, v9
  v_dot2c_f32_bf16 v66, v131, v38
  v_dot2c_f32_bf16 v67, v131, v9
  v_lshlrev_b32 v10, 16, v39
  s_waitcnt vmcnt(24)
  v_dot2c_f32_bf16 v52, v132, v39
  v_dot2c_f32_bf16 v53, v132, v10
  v_dot2c_f32_bf16 v54, v133, v39
  v_dot2c_f32_bf16 v55, v133, v10
  v_dot2c_f32_bf16 v56, v134, v39
  v_dot2c_f32_bf16 v57, v134, v10
  v_dot2c_f32_bf16 v58, v135, v39
  v_dot2c_f32_bf16 v59, v135, v10
  v_dot2c_f32_bf16 v60, v136, v39
  v_dot2c_f32_bf16 v61, v136, v10
  v_dot2c_f32_bf16 v62, v137, v39
  v_dot2c_f32_bf16 v63, v137, v10
  v_dot2c_f32_bf16 v64, v138, v39
  v_dot2c_f32_bf16 v65, v138, v10
  v_dot2c_f32_bf16 v66, v139, v39
  v_dot2c_f32_bf16 v67, v139, v10
  v_lshlrev_b32 v9, 16, v40
  s_waitcnt vmcnt(22)
  v_dot2c_f32_bf16 v52, v140, v40
  v_dot2c_f32_bf16 v53, v140, v9
  v_dot2c_f32_bf16 v54, v141, v40
  v_dot2c_f32_bf16 v55, v141, v9
  v_dot2c_f32_bf16 v56, v142, v40
  v_dot2c_f32_bf16 v57, v142, v9
  v_dot2c_f32_bf16 v58, v143, v40
  v_dot2c_f32_bf16 v59, v143, v9
  v_dot2c_f32_bf16 v60, v144, v40
  v_dot2c_f32_bf16 v61, v144, v9
  v_dot2c_f32_bf16 v62, v145, v40
  v_dot2c_f32_bf16 v63, v145, v9
  v_dot2c_f32_bf16 v64, v146, v40
  v_dot2c_f32_bf16 v65, v146, v9
  v_dot2c_f32_bf16 v66, v147, v40
  v_dot2c_f32_bf16 v67, v147, v9
  v_lshlrev_b32 v10, 16, v41
  s_waitcnt vmcnt(20)
  v_dot2c_f32_bf16 v52, v148, v41
  v_dot2c_f32_bf16 v53, v148, v10
  v_dot2c_f32_bf16 v54, v149, v41
  v_dot2c_f32_bf16 v55, v149, v10
  v_dot2c_f32_bf16 v56, v150, v41
  v_dot2c_f32_bf16 v57, v150, v10
  v_dot2c_f32_bf16 v58, v151, v41
  v_dot2c_f32_bf16 v59, v151, v10
  v_dot2c_f32_bf16 v60, v152, v41
  v_dot2c_f32_bf16 v61, v152, v10
  v_dot2c_f32_bf16 v62, v153, v41
  v_dot2c_f32_bf16 v63, v153, v10
  v_dot2c_f32_bf16 v64, v154, v41
  v_dot2c_f32_bf16 v65, v154, v10
  v_dot2c_f32_bf16 v66, v155, v41
  v_dot2c_f32_bf16 v67, v155, v10
  v_lshlrev_b32 v9, 16, v42
  s_waitcnt vmcnt(18)
  v_dot2c_f32_bf16 v52, v156, v42
  v_dot2c_f32_bf16 v53, v156, v9
  v_dot2c_f32_bf16 v54, v157, v42
  v_dot2c_f32_bf16 v55, v157, v9
  v_dot2c_f32_bf16 v56, v158, v42
  v_dot2c_f32_bf16 v57, v158, v9
  v_dot2c_f32_bf16 v58, v159, v42
  v_dot2c_f32_bf16 v59, v159, v9
  v_dot2c_f32_bf16 v60, v160, v42
  v_dot2c_f32_bf16 v61, v160, v9
  v_dot2c_f32_bf16 v62, v161, v42
  v_dot2c_f32_bf16 v63, v161, v9
  v_dot2c_f32_bf16 v64, v162, v42
  v_dot2c_f32_bf16 v65, v162, v9
  v_dot2c_f32_bf16 v66, v163, v42
  v_dot2c_f32_bf16 v67, v163, v9
  v_lshlrev_b32 v10, 16, v43
  s_waitcnt vmcnt(16)
  v_dot2c_f32_bf16 v52, v164, v43
  v_dot2c_f32_bf16 v53, v164, v10
  v_dot2c_f32_bf16 v54, v165, v43
  v_dot2c_f32_bf16 v55, v165, v10
  v_dot2c_f32_bf16 v56, v166, v43
  v_dot2c_f32_bf16 v57, v166, v10
  v_dot2c_f32_bf16 v58, v167, v43
  v_dot2c_f32_bf16 v59, v167, v10
  v_dot2c_f32_bf16 v60, v168, v43
  v_dot2c_f32_bf16 v61, v168, v10
  v_dot2c_f32_bf16 v62, v169, v43
  v_dot2c_f32_bf16 v63, v169, v10
  v_dot2c_f32_bf16 v64, v170, v43
  v_dot2c_f32_bf16 v65, v170, v10
  v_dot2c_f32_bf16 v66, v171, v43
  v_dot2c_f32_bf16 v67, v171, v10
  v_lshlrev_b32 v9, 16, v44
  s_waitcnt vmcnt(14)
  v_dot2c_f32_bf16 v52, v172, v44
  v_dot2c_f32_bf16 v53, v172, v9
  v_dot2c_f32_bf16 v54, v173, v44
  v_dot2c_f32_bf16 v55, v173, v9
  v_dot2c_f32_bf16 v56, v174, v44
  v_dot2c_f32_bf16 v57, v174, v9
  v_dot2c_f32_bf16 v58, v175, v44
  v_dot2c_f32_bf16 v59, v175, v9
  v_dot2c_f32_bf16 v60, v176, v44
  v_dot2c_f32_bf16 v61, v176, v9
  v_dot2c_f32_bf16 v62, v177, v44
  v_dot2c_f32_bf16 v63, v177, v9
  v_dot2c_f32_bf16 v64, v178, v44
  v_dot2c_f32_bf16 v65, v178, v9
  v_dot2c_f32_bf16 v66, v179, v44
  v_dot2c_f32_bf16 v67, v179, v9
  v_lshlrev_b32 v10, 16, v45
  s_waitcnt vmcnt(12)
  v_dot2c_f32_bf16 v52, v180, v45
  v_dot2c_f32_bf16 v53, v180, v10
  v_dot2c_f32_bf16 v54, v181, v45
  v_dot2c_f32_bf16 v55, v181, v10
  v_dot2c_f32_bf16 v56, v182, v45
  v_dot2c_f32_bf16 v57, v182, v10
  v_dot2c_f32_bf16 v58, v183, v45
  v_dot2c_f32_bf16 v59, v183, v10
  v_dot2c_f32_bf16 v60, v184, v45
  v_dot2c_f32_bf16 v61, v184, v10
  v_dot2c_f32_bf16 v62, v185, v45
  v_dot2c_f32_bf16 v63, v185, v10
  v_dot2c_f32_bf16 v64, v186, v45
  v_dot2c_f32_bf16 v65, v186, v10
  v_dot2c_f32_bf16 v66, v187, v45
  v_dot2c_f32_bf16 v67, v187, v10
  v_lshlrev_b32 v9, 16, v46
  s_waitcnt vmcnt(10)
  v_dot2c_f32_bf16 v52, v188, v46
  v_dot2c_f32_bf16 v53, v188, v9
  v_dot2c_f32_bf16 v54, v189, v46
  v_dot2c_f32_bf16 v55, v189, v9
  v_dot2c_f32_bf16 v56, v190, v46
  v_dot2c_f32_bf16 v57, v190, v9
  v_dot2c_f32_bf16 v58, v191, v46
  v_dot2c_f32_bf16 v59, v191, v9
  v_dot2c_f32_bf16 v60, v192, v46
  v_dot2c_f32_bf16 v61, v192, v9
  v_dot2c_f32_bf16 v62, v193, v46
  v_dot2c_f32_bf16 v63, v193, v9
  v_dot2c_f32_bf16 v64, v194, v46
  v_dot2c_f32_bf16 v65, v194, v9
  v_dot2c_f32_bf16 v66, v195, v46
  v_dot2c_f32_bf16 v67, v195, v9
  v_lshlrev_b32 v10, 16, v47
  s_waitcnt vmcnt(8)
  v_dot2c_f32_bf16 v52, v196, v47
  v_dot2c_f32_bf16 v53, v196, v10
  v_dot2c_f32_bf16 v54, v197, v47
  v_dot2c_f32_bf16 v55, v197, v10
  v_dot2c_f32_bf16 v56, v198, v47
  v_dot2c_f32_bf16 v57, v198, v10
  v_dot2c_f32_bf16 v58, v199, v47
  v_dot2c_f32_bf16 v59, v199, v10
  v_dot2c_f32_bf16 v60, v200, v47
  v_dot2c_f32_bf16 v61, v200, v10
  v_dot2c_f32_bf16 v62, v201, v47
  v_dot2c_f32_bf16 v63, v201, v10
  v_dot2c_f32_bf16 v64, v202, v47
  v_dot2c_f32_bf16 v65, v202, v10
  v_dot2c_f32_bf16 v66, v203, v47
  v_dot2c_f32_bf16 v67, v203, v10
  v_lshlrev_b32 v9, 16, v48
  s_waitcnt vmcnt(6)
  v_dot2c_f32_bf16 v52, v204, v48
  v_dot2c_f32_bf16 v53, v204, v9
  v_dot2c_f32_bf16 v54, v205, v48
  v_dot2c_f32_bf16 v55, v205, v9
  v_dot2c_f32_bf16 v56, v206, v48
  v_dot2c_f32_bf16 v57, v206, v9
  v_dot2c_f32_bf16 v58, v207, v48
  v_dot2c_f32_bf16 v59, v207, v9
  v_dot2c_f32_bf16 v60, v208, v48
  v_dot2c_f32_bf16 v61, v208, v9
  v_dot2c_f32_bf16 v62, v209, v48
  v_dot2c_f32_bf16 v63, v209, v9
  v_dot2c_f32_bf16 v64, v210, v48
  v_dot2c_f32_bf16 v65, v210, v9
  v_dot2c_f32_bf16 v66, v211, v48
  v_dot2c_f32_bf16 v67, v211, v9
  v_lshlrev_b32 v10, 16, v49
  s_waitcnt vmcnt(4)
  v_dot2c_f32_bf16 v52, v212, v49
  v_dot2c_f32_bf16 v53, v212, v10
  v_dot2c_f32_bf16 v54, v213, v49
  v_dot2c_f32_bf16 v55, v213, v10
  v_dot2c_f32_bf16 v56, v214, v49
  v_dot2c_f32_bf16 v57, v214, v10
  v_dot2c_f32_bf16 v58, v215, v49
  v_dot2c_f32_bf16 v59, v215, v10
  v_dot2c_f32_bf16 v60, v216, v49
  v_dot2c_f32_bf16 v61, v216, v10
  v_dot2c_f32_bf16 v62, v217, v49
  v_dot2c_f32_bf16 v63, v217, v10
  v_dot2c_f32_bf16 v64, v218, v49
  v_dot2c_f32_bf16 v65, v218, v10
  v_dot2c_f32_bf16 v66, v219, v49
  v_dot2c_f32_bf16 v67, v219, v10
  v_lshlrev_b32 v9, 16, v50
  s_waitcnt vmcnt(2)
  v_dot2c_f32_bf16 v52, v220, v50
  v_dot2c_f32_bf16 v53, v220, v9
  v_dot2c_f32_bf16 v54, v221, v50
  v_dot2c_f32_bf16 v55, v221, v9
  v_dot2c_f32_bf16 v56, v222, v50
  v_dot2c_f32_bf16 v57, v222, v9
  v_dot2c_f32_bf16 v58, v223, v50
  v_dot2c_f32_bf16 v59, v223, v9
  v_dot2c_f32_bf16 v60, v224, v50
  v_dot2c_f32_bf16 v61, v224, v9
  v_dot2c_f32_bf16 v62, v225, v50
  v_dot2c_f32_bf16 v63, v225, v9
  v_dot2c_f32_bf16 v64, v226, v50
  v_dot2c_f32_bf16 v65, v226, v9
  v_dot2c_f32_bf16 v66, v227, v50
  v_dot2c_f32_bf16 v67, v227, v9
  v_lshlrev_b32 v10, 16, v51
  s_waitcnt vmcnt(0)
  v_dot2c_f32_bf16 v52, v228, v51
  v_dot2c_f32_bf16 v53, v228, v10
  v_dot2c_f32_bf16 v54, v229, v51
  v_dot2c_f32_bf16 v55, v229, v10
  v_dot2c_f32_bf16 v56, v230, v51
  v_dot2c_f32_bf16 v57, v230, v10
  v_dot2c_f32_bf16 v58, v231, v51
  v_dot2c_f32_bf16 v59, v231, v10
  v_dot2c_f32_bf16 v60, v232, v51
  v_dot2c_f32_bf16 v61, v232, v10
  v_dot2c_f32_bf16 v62, v233, v51
  v_dot2c_f32_bf16 v63, v233, v10
  v_dot2c_f32_bf16 v64, v234, v51
  v_dot2c_f32_bf16 v65, v234, v10
  v_dot2c_f32_bf16 v66, v235, v51
  v_dot2c_f32_bf16 v67, v235, v10
  v_permlane32_swap_b32 v52, v56
  v_permlane32_swap_b32 v53, v57
  v_permlane32_swap_b32 v54, v58
  v_permlane32_swap_b32 v55, v59
  v_permlane32_swap_b32 v60, v64
  v_permlane32_swap_b32 v61, v65
  v_permlane32_swap_b32 v62, v66
  v_permlane32_swap_b32 v63, v67
  v_add_f32 v52, v52, v56
  v_add_f32 v53, v53, v57
  v_add_f32 v54, v54, v58
  v_add_f32 v55, v55, v59
  v_add_f32 v60, v60, v64
  v_add_f32 v61, v61, v65
  v_add_f32 v62, v62, v66
  v_add_f32 v63, v63, v67
  v_permlane16_swap_b32 v52, v54
  v_permlane16_swap_b32 v53, v55
  v_permlane16_swap_b32 v60, v62
  v_permlane16_swap_b32 v61, v63
  v_add_f32 v52, v52, v54
  v_add_f32 v53, v53, v55
  v_add_f32 v60, v60, v62
  v_add_f32 v61, v61, v63
  v_add_f32_dpp v52, v52, v52 row_ror:8 row_mask:0xf bank_mask:0xf
  v_add_f32_dpp v53, v53, v53 row_ror:8 row_mask:0xf bank_mask:0xf
  v_add_f32_dpp v60, v60, v60 row_ror:8 row_mask:0xf bank_mask:0xf
  v_add_f32_dpp v61, v61, v61 row_ror:8 row_mask:0xf bank_mask:0xf
  v_cndmask_b32 v52, v52, v53, s[60:61]
  v_cndmask_b32 v60, v60, v61, s[60:61]
  s_lshl_b32 s62, s3, 9
  v_add_u32 v6, s62, v19
  ds_write_b32 v6, v52 offset:4160
  ds_write_b32 v6, v60 offset:4416
  s_mov_b64 exec, 1
  ds_add_u32 v21, v20 offset:32
  s_mov_b64 exec, -1
  s_cmp_lg_u32 s3, 3
  s_cbranch_scc1 L_Hjoin_22
  s_mov_b32 s64, 262144
L_cw_25:
  ds_read_b32 v5, v21 offset:32
  s_waitcnt lgkmcnt(0)
  v_readfirstlane_b32 s62, v5
  s_cmp_ge_u32 s62, 4
  s_cbranch_scc1 L_cw_done_26
  s_sub_u32 s64, s64, 1
  s_cbranch_scc1 L_cw_done_26
  s_branch L_cw_25
L_cw_done_26:
  ds_read_b32 v52, v1 offset:4160
  ds_read_b32 v56, v1 offset:4416
  ds_read_b32 v53, v1 offset:4672
  ds_read_b32 v57, v1 offset:4928
  ds_read_b32 v54, v1 offset:5184
  ds_read_b32 v58, v1 offset:5440
  ds_read_b32 v55, v1 offset:5696
  ds_read_b32 v59, v1 offset:5952
  s_waitcnt lgkmcnt(0)
  v_add_f32 v52, v52, v53
  v_add_f32 v54, v54, v55
  v_add_f32 v52, v52, v54
  v_add_f32 v56, v56, v57
  v_add_f32 v58, v58, v59
  v_add_f32 v56, v56, v58
  v_cvt_pk_bf16_f32 v52, 0, v52
  v_cvt_pk_bf16_f32 v56, 0, v56
  v_mul_f32 v52, v52, v56
  v_cvt_pk_bf16_f32 v52, v52, 0
  v_mov_b32 v53, s65
  s_lshl_b32 s62, s14, 9
  s_add_u32 s62, s62, 65536
  buffer_store_dwordx2 v[52:53], v17, s[36:39], s62 offen sc1
  s_branch L_Hjoin_22
L_taskB_21:
  s_sub_u32 s62, s15, 6
  s_lshl_b32 s62, s62, 3
  s_sub_u32 s97, s14, 24
  s_add_u32 s97, s97, s62
  s_cmp_ge_u32 s97, 10
  s_cbranch_scc1 L_Hjoin_22
  s_mov_b32 s64, 262144
L_cw_27:
  ds_read_b32 v5, v21 offset:4
  s_waitcnt lgkmcnt(0)
  v_readfirstlane_b32 s62, v5
  s_cmp_ge_u32 s62, 1
  s_cbranch_scc1 L_cw_done_28
  s_sub_u32 s64, s64, 1
  s_cbranch_scc1 L_cw_done_28
  s_sleep 2
  s_branch L_cw_27
L_cw_done_28:
  s_mov_b32 s52, s20
  s_mov_b32 s53, s21
  s_mov_b32 s54, 1966080
  s_mov_b32 s55, 0x20000
  s_movk_i32 s63, 1280
  v_lshlrev_b32 v5, 4, v4
  v_mad_u32_u24 v16, v3, s63, v5
  s_mul_i32 s66, s3, 491520
  s_lshl_b32 s63, s97, 7
  s_add_u32 s66, s66, s63
  buffer_load_dwordx4 v[76:79], v16, s[52:55], s66 offen nt
  s_add_u32 s66, s66, 10240
  buffer_load_dwordx4 v[80:83], v16, s[52:55], s66 offen nt
  s_add_u32 s66, s66, 10240
  buffer_load_dwordx4 v[84:87], v16, s[52:55], s66 offen nt
  s_add_u32 s66, s66, 10240
  buffer_load_dwordx4 v[88:91], v16, s[52:55], s66 offen nt
  s_add_u32 s66, s66, 10240
  buffer_load_dwordx4 v[92:95], v16, s[52:55], s66 offen nt
  s_add_u32 s66, s66, 10240
  buffer_load_dwordx4 v[96:99], v16, s[52:55], s66 offen nt
  s_add_u32 s66, s66, 10240
  buffer_load_dwordx4 v[100:103], v16, s[52:55], s66 offen nt
  s_add_u32 s66, s66, 10240
  buffer_load_dwordx4 v[104:107], v16, s[52:55], s66 offen nt
  s_add_u32 s66, s66, 10240
  buffer_load_dwordx4 v[108:111], v16, s[52:55], s66 offen nt
  s_add_u32 s66, s66, 10240
  buffer_load_dwordx4 v[112:115], v16, s[52:55], s66 offen nt
  s_add_u32 s66, s66, 10240
  buffer_load_dwordx4 v[116:119], v16, s[52:55], s66 offen nt
  s_add_u32 s66, s66, 10240
  buffer_load_dwordx4 v[120:123], v16, s[52:55], s66 offen nt
  s_add_u32 s66, s66, 10240
  buffer_load_dwordx4 v[124:127], v16, s[52:55], s66 offen nt
  s_add_u32 s66, s66, 10240
  buffer_load_dwordx4 v[128:131], v16, s[52:55], s66 offen nt
  s_add_u32 s66, s66, 10240
  buffer_load_dwordx4 v[132:135], v16, s[52:55], s66 offen nt
  s_add_u32 s66, s66, 10240
  buffer_load_dwordx4 v[136:139], v16, s[52:55], s66 offen nt
  s_add_u32 s66, s66, 10240
  buffer_load_dwordx4 v[140:143], v16, s[52:55], s66 offen nt
  s_add_u32 s66, s66, 10240
  buffer_load_dwordx4 v[144:147], v16, s[52:55], s66 offen nt
  s_add_u32 s66, s66, 10240
  buffer_load_dwordx4 v[148:151], v16, s[52:55], s66 offen nt
  s_add_u32 s66, s66, 10240
  buffer_load_dwordx4 v[152:155], v16, s[52:55], s66 offen nt
  s_add_u32 s66, s66, 10240
  buffer_load_dwordx4 v[156:159], v16, s[52:55], s66 offen nt
  s_add_u32 s66, s66, 10240
  buffer_load_dwordx4 v[160:163], v16, s[52:55], s66 offen nt
  s_add_u32 s66, s66, 10240
  buffer_load_dwordx4 v[164:167], v16, s[52:55], s66 offen nt
  s_add_u32 s66, s66, 10240
  buffer_load_dwordx4 v[168:171], v16, s[52:55], s66 offen nt
  s_add_u32 s66, s66, 10240
  buffer_load_dwordx4 v[172:175], v16, s[52:55], s66 offen nt
  s_add_u32 s66, s66, 10240
  buffer_load_dwordx4 v[176:179], v16, s[52:55], s66 offen nt
  s_add_u32 s66, s66, 10240
  buffer_load_dwordx4 v[180:183], v16, s[52:55], s66 offen nt
  s_add_u32 s66, s66, 10240
  buffer_load_dwordx4 v[184:187], v16, s[52:55], s66 offen nt
  s_add_u32 s66, s66, 10240
  buffer_load_dwordx4 v[188:191], v16, s[52:55], s66 offen nt
  s_add_u32 s66, s66, 10240
  buffer_load_dwordx4 v[192:195], v16, s[52:55], s66 offen nt
  s_add_u32 s66, s66, 10240
  buffer_load_dwordx4 v[196:199], v16, s[52:55], s66 offen nt
  s_add_u32 s66, s66, 10240
  buffer_load_dwordx4 v[200:203], v16, s[52:55], s66 offen nt
  s_add_u32 s66, s66, 10240
  v_lshlrev_b32 v216, 4, v0
  s_mul_i32 s69, s3, 3072
  s_add_u32 s69, s69, 65536
  s_mov_b32 s64, 65536
L_pollH_29:
  buffer_load_dwordx4 v[204:207], v216, s[36:39], s69 offen offset:0 sc1
  buffer_load_dwordx4 v[208:211], v216, s[36:39], s69 offen offset:1024 sc1
  buffer_load_dwordx4 v[212:215], v216, s[36:39], s69 offen offset:2048 sc1
  s_waitcnt vmcnt(0)
  v_max3_u32 v5, v205, v207, v209
  v_max3_u32 v5, v5, v211, v213
  v_max_u32 v5, v5, v215
  v_min3_u32 v6, v205, v207, v209
  v_min3_u32 v6, v6, v211, v213
  v_min_u32 v6, v6, v215
  v_xor_b32 v5, s65, v5
  v_xor_b32 v6, s65, v6
  v_or_b32 v5, v5, v6
  v_cmp_ne_u32 vcc, 0, v5
  s_cbranch_vccz L_pollH_done_30
  s_sub_u32 s64, s64, 1
  s_cbranch_scc1 L_pollH_done_30
  s_sleep 8
  s_branch L_pollH_29
L_pollH_done_30:
  s_mul_i32 s62, s3, 768
  v_add_u32 v6, s62, v1
  v_lshl_add_u32 v7, v3, 1, s62
  v_and_b32 v204, 0xffff, v204
  v_lshl_or_b32 v204, v206, 16, v204
  ds_write_b32 v6, v204 offset:4160
  v_and_b32 v208, 0xffff, v208
  v_lshl_or_b32 v208, v210, 16, v208
  ds_write_b32 v6, v208 offset:4416
  v_and_b32 v212, 0xffff, v212
  v_lshl_or_b32 v212, v214, 16, v212
  ds_write_b32 v6, v212 offset:4672
  v_mov_b32 v52, 0
  v_mov_b32 v53, 0
  v_mov_b32 v54, 0
  v_mov_b32 v55, 0
  v_mov_b32 v56, 0
  v_mov_b32 v57, 0
  v_mov_b32 v58, 0
  v_mov_b32 v59, 0
  ds_read_u16 v32, v7 offset:4160
  ds_read_u16 v33, v7 offset:4176
  ds_read_u16 v34, v7 offset:4192
  ds_read_u16 v35, v7 offset:4208
  ds_read_u16 v36, v7 offset:4224
  ds_read_u16 v37, v7 offset:4240
  ds_read_u16 v38, v7 offset:4256
  ds_read_u16 v39, v7 offset:4272
  ds_read_u16 v40, v7 offset:4288
  ds_read_u16 v41, v7 offset:4304
  ds_read_u16 v42, v7 offset:4320
  ds_read_u16 v43, v7 offset:4336
  ds_read_u16 v44, v7 offset:4352
  ds_read_u16 v45, v7 offset:4368
  ds_read_u16 v46, v7 offset:4384
  ds_read_u16 v47, v7 offset:4400
  s_waitcnt vmcnt(0) lgkmcnt(0)
  v_lshlrev_b32 v9, 16, v32
  v_dot2c_f32_bf16 v52, v76, v32
  v_dot2c_f32_bf16 v53, v76, v9
  v_dot2c_f32_bf16 v54, v77, v32
  v_dot2c_f32_bf16 v55, v77, v9
  v_dot2c_f32_bf16 v56, v78, v32
  v_dot2c_f32_bf16 v57, v78, v9
  v_dot2c_f32_bf16 v58, v79, v32
  v_dot2c_f32_bf16 v59, v79, v9
  v_lshlrev_b32 v10, 16, v33
  v_dot2c_f32_bf16 v52, v80, v33
  v_dot2c_f32_bf16 v53, v80, v10
  v_dot2c_f32_bf16 v54, v81, v33
  v_dot2c_f32_bf16 v55, v81, v10
  v_dot2c_f32_bf16 v56, v82, v33
  v_dot2c_f32_bf16 v57, v82, v10
  v_dot2c_f32_bf16 v58, v83, v33
  v_dot2c_f32_bf16 v59, v83, v10
  v_lshlrev_b32 v9, 16, v34
  v_dot2c_f32_bf16 v52, v84, v34
  v_dot2c_f32_bf16 v53, v84, v9
  v_dot2c_f32_bf16 v54, v85, v34
  v_dot2c_f32_bf16 v55, v85, v9
  v_dot2c_f32_bf16 v56, v86, v34
  v_dot2c_f32_bf16 v57, v86, v9
  v_dot2c_f32_bf16 v58, v87, v34
  v_dot2c_f32_bf16 v59, v87, v9
  v_lshlrev_b32 v10, 16, v35
  v_dot2c_f32_bf16 v52, v88, v35
  v_dot2c_f32_bf16 v53, v88, v10
  v_dot2c_f32_bf16 v54, v89, v35
  v_dot2c_f32_bf16 v55, v89, v10
  v_dot2c_f32_bf16 v56, v90, v35
  v_dot2c_f32_bf16 v57, v90, v10
  v_dot2c_f32_bf16 v58, v91, v35
  v_dot2c_f32_bf16 v59, v91, v10
  v_lshlrev_b32 v9, 16, v36
  v_dot2c_f32_bf16 v52, v92, v36
  v_dot2c_f32_bf16 v53, v92, v9
  v_dot2c_f32_bf16 v54, v93, v36
  v_dot2c_f32_bf16 v55, v93, v9
  v_dot2c_f32_bf16 v56, v94, v36
  v_dot2c_f32_bf16 v57, v94, v9
  v_dot2c_f32_bf16 v58, v95, v36
  v_dot2c_f32_bf16 v59, v95, v9
  v_lshlrev_b32 v10, 16, v37
  v_dot2c_f32_bf16 v52, v96, v37
  v_dot2c_f32_bf16 v53, v96, v10
  v_dot2c_f32_bf16 v54, v97, v37
  v_dot2c_f32_bf16 v55, v97, v10
  v_dot2c_f32_bf16 v56, v98, v37
  v_dot2c_f32_bf16 v57, v98, v10
  v_dot2c_f32_bf16 v58, v99, v37
  v_dot2c_f32_bf16 v59, v99, v10
  v_lshlrev_b32 v9, 16, v38
  v_dot2c_f32_bf16 v52, v100, v38
  v_dot2c_f32_bf16 v53, v100, v9
  v_dot2c_f32_bf16 v54, v101, v38
  v_dot2c_f32_bf16 v55, v101, v9
  v_dot2c_f32_bf16 v56, v102, v38
  v_dot2c_f32_bf16 v57, v102, v9
  v_dot2c_f32_bf16 v58, v103, v38
  v_dot2c_f32_bf16 v59, v103, v9
  v_lshlrev_b32 v10, 16, v39
  v_dot2c_f32_bf16 v52, v104, v39
  v_dot2c_f32_bf16 v53, v104, v10
  v_dot2c_f32_bf16 v54, v105, v39
  v_dot2c_f32_bf16 v55, v105, v10
  v_dot2c_f32_bf16 v56, v106, v39
  v_dot2c_f32_bf16 v57, v106, v10
  v_dot2c_f32_bf16 v58, v107, v39
  v_dot2c_f32_bf16 v59, v107, v10
  v_lshlrev_b32 v9, 16, v40
  v_dot2c_f32_bf16 v52, v108, v40
  v_dot2c_f32_bf16 v53, v108, v9
  v_dot2c_f32_bf16 v54, v109, v40
  v_dot2c_f32_bf16 v55, v109, v9
  v_dot2c_f32_bf16 v56, v110, v40
  v_dot2c_f32_bf16 v57, v110, v9
  v_dot2c_f32_bf16 v58, v111, v40
  v_dot2c_f32_bf16 v59, v111, v9
  v_lshlrev_b32 v10, 16, v41
  v_dot2c_f32_bf16 v52, v112, v41
  v_dot2c_f32_bf16 v53, v112, v10
  v_dot2c_f32_bf16 v54, v113, v41
  v_dot2c_f32_bf16 v55, v113, v10
  v_dot2c_f32_bf16 v56, v114, v41
  v_dot2c_f32_bf16 v57, v114, v10
  v_dot2c_f32_bf16 v58, v115, v41
  v_dot2c_f32_bf16 v59, v115, v10
  v_lshlrev_b32 v9, 16, v42
  v_dot2c_f32_bf16 v52, v116, v42
  v_dot2c_f32_bf16 v53, v116, v9
  v_dot2c_f32_bf16 v54, v117, v42
  v_dot2c_f32_bf16 v55, v117, v9
  v_dot2c_f32_bf16 v56, v118, v42
  v_dot2c_f32_bf16 v57, v118, v9
  v_dot2c_f32_bf16 v58, v119, v42
  v_dot2c_f32_bf16 v59, v119, v9
  v_lshlrev_b32 v10, 16, v43
  v_dot2c_f32_bf16 v52, v120, v43
  v_dot2c_f32_bf16 v53, v120, v10
  v_dot2c_f32_bf16 v54, v121, v43
  v_dot2c_f32_bf16 v55, v121, v10
  v_dot2c_f32_bf16 v56, v122, v43
  v_dot2c_f32_bf16 v57, v122, v10
  v_dot2c_f32_bf16 v58, v123, v43
  v_dot2c_f32_bf16 v59, v123, v10
  v_lshlrev_b32 v9, 16, v44
  v_dot2c_f32_bf16 v52, v124, v44
  v_dot2c_f32_bf16 v53, v124, v9
  v_dot2c_f32_bf16 v54, v125, v44
  v_dot2c_f32_bf16 v55, v125, v9
  v_dot2c_f32_bf16 v56, v126, v44
  v_dot2c_f32_bf16 v57, v126, v9
  v_dot2c_f32_bf16 v58, v127, v44
  v_dot2c_f32_bf16 v59, v127, v9
  v_lshlrev_b32 v10, 16, v45
  v_dot2c_f32_bf16 v52, v128, v45
  v_dot2c_f32_bf16 v53, v128, v10
  v_dot2c_f32_bf16 v54, v129, v45
  v_dot2c_f32_bf16 v55, v129, v10
  v_dot2c_f32_bf16 v56, v130, v45
  v_dot2c_f32_bf16 v57, v130, v10
  v_dot2c_f32_bf16 v58, v131, v45
  v_dot2c_f32_bf16 v59, v131, v10
  v_lshlrev_b32 v9, 16, v46
  v_dot2c_f32_bf16 v52, v132, v46
  v_dot2c_f32_bf16 v53, v132, v9
  v_dot2c_f32_bf16 v54, v133, v46
  v_dot2c_f32_bf16 v55, v133, v9
  v_dot2c_f32_bf16 v56, v134, v46
  v_dot2c_f32_bf16 v57, v134, v9
  v_dot2c_f32_bf16 v58, v135, v46
  v_dot2c_f32_bf16 v59, v135, v9
  v_lshlrev_b32 v10, 16, v47
  v_dot2c_f32_bf16 v52, v136, v47
  v_dot2c_f32_bf16 v53, v136, v10
  v_dot2c_f32_bf16 v54, v137, v47
  v_dot2c_f32_bf16 v55, v137, v10
  v_dot2c_f32_bf16 v56, v138, v47
  v_dot2c_f32_bf16 v57, v138, v10
  v_dot2c_f32_bf16 v58, v139, v47
  v_dot2c_f32_bf16 v59, v139, v10
  buffer_load_dwordx4 v[76:79], v16, s[52:55], s66 offen nt
  s_add_u32 s66, s66, 10240
  buffer_load_dwordx4 v[80:83], v16, s[52:55], s66 offen nt
  s_add_u32 s66, s66, 10240
  buffer_load_dwordx4 v[84:87], v16, s[52:55], s66 offen nt
  s_add_u32 s66, s66, 10240
  buffer_load_dwordx4 v[88:91], v16, s[52:55], s66 offen nt
  s_add_u32 s66, s66, 10240
  buffer_load_dwordx4 v[92:95], v16, s[52:55], s66 offen nt
  s_add_u32 s66, s66, 10240
  buffer_load_dwordx4 v[96:99], v16, s[52:55], s66 offen nt
  s_add_u32 s66, s66, 10240
  buffer_load_dwordx4 v[100:103], v16, s[52:55], s66 offen nt
  s_add_u32 s66, s66, 10240
  buffer_load_dwordx4 v[104:107], v16, s[52:55], s66 offen nt
  s_add_u32 s66, s66, 10240
  buffer_load_dwordx4 v[108:111], v16, s[52:55], s66 offen nt
  s_add_u32 s66, s66, 10240
  buffer_load_dwordx4 v[112:115], v16, s[52:55], s66 offen nt
  s_add_u32 s66, s66, 10240
  buffer_load_dwordx4 v[116:119], v16, s[52:55], s66 offen nt
  s_add_u32 s66, s66, 10240
  buffer_load_dwordx4 v[120:123], v16, s[52:55], s66 offen nt
  s_add_u32 s66, s66, 10240
  buffer_load_dwordx4 v[124:127], v16, s[52:55], s66 offen nt
  s_add_u32 s66, s66, 10240
  buffer_load_dwordx4 v[128:131], v16, s[52:55], s66 offen nt
  s_add_u32 s66, s66, 10240
  buffer_load_dwordx4 v[132:135], v16, s[52:55], s66 offen nt
  s_add_u32 s66, s66, 10240
  buffer_load_dwordx4 v[136:139], v16, s[52:55], s66 offen nt
  ds_read_u16 v32, v7 offset:4416
  ds_read_u16 v33, v7 offset:4432
  ds_read_u16 v34, v7 offset:4448
  ds_read_u16 v35, v7 offset:4464
  ds_read_u16 v36, v7 offset:4480
  ds_read_u16 v37, v7 offset:4496
  ds_read_u16 v38, v7 offset:4512
  ds_read_u16 v39, v7 offset:4528
  ds_read_u16 v40, v7 offset:4544
  ds_read_u16 v41, v7 offset:4560
  ds_read_u16 v42, v7 offset:4576
  ds_read_u16 v43, v7 offset:4592
  ds_read_u16 v44, v7 offset:4608
  ds_read_u16 v45, v7 offset:4624
  ds_read_u16 v46, v7 offset:4640
  ds_read_u16 v47, v7 offset:4656
  s_waitcnt vmcnt(0) lgkmcnt(0)
  v_lshlrev_b32 v9, 16, v32
  v_dot2c_f32_bf16 v52, v140, v32
  v_dot2c_f32_bf16 v53, v140, v9
  v_dot2c_f32_bf16 v54, v141, v32
  v_dot2c_f32_bf16 v55, v141, v9
  v_dot2c_f32_bf16 v56, v142, v32
  v_dot2c_f32_bf16 v57, v142, v9
  v_dot2c_f32_bf16 v58, v143, v32
  v_dot2c_f32_bf16 v59, v143, v9
  v_lshlrev_b32 v10, 16, v33
  v_dot2c_f32_bf16 v52, v144, v33
  v_dot2c_f32_bf16 v53, v144, v10
  v_dot2c_f32_bf16 v54, v145, v33
  v_dot2c_f32_bf16 v55, v145, v10
  v_dot2c_f32_bf16 v56, v146, v33
  v_dot2c_f32_bf16 v57, v146, v10
  v_dot2c_f32_bf16 v58, v147, v33
  v_dot2c_f32_bf16 v59, v147, v10
  v_lshlrev_b32 v9, 16, v34
  v_dot2c_f32_bf16 v52, v148, v34
  v_dot2c_f32_bf16 v53, v148, v9
  v_dot2c_f32_bf16 v54, v149, v34
  v_dot2c_f32_bf16 v55, v149, v9
  v_dot2c_f32_bf16 v56, v150, v34
  v_dot2c_f32_bf16 v57, v150, v9
  v_dot2c_f32_bf16 v58, v151, v34
  v_dot2c_f32_bf16 v59, v151, v9
  v_lshlrev_b32 v10, 16, v35
  v_dot2c_f32_bf16 v52, v152, v35
  v_dot2c_f32_bf16 v53, v152, v10
  v_dot2c_f32_bf16 v54, v153, v35
  v_dot2c_f32_bf16 v55, v153, v10
  v_dot2c_f32_bf16 v56, v154, v35
  v_dot2c_f32_bf16 v57, v154, v10
  v_dot2c_f32_bf16 v58, v155, v35
  v_dot2c_f32_bf16 v59, v155, v10
  v_lshlrev_b32 v9, 16, v36
  v_dot2c_f32_bf16 v52, v156, v36
  v_dot2c_f32_bf16 v53, v156, v9
  v_dot2c_f32_bf16 v54, v157, v36
  v_dot2c_f32_bf16 v55, v157, v9
  v_dot2c_f32_bf16 v56, v158, v36
  v_dot2c_f32_bf16 v57, v158, v9
  v_dot2c_f32_bf16 v58, v159, v36
  v_dot2c_f32_bf16 v59, v159, v9
  v_lshlrev_b32 v10, 16, v37
  v_dot2c_f32_bf16 v52, v160, v37
  v_dot2c_f32_bf16 v53, v160, v10
  v_dot2c_f32_bf16 v54, v161, v37
  v_dot2c_f32_bf16 v55, v161, v10
  v_dot2c_f32_bf16 v56, v162, v37
  v_dot2c_f32_bf16 v57, v162, v10
  v_dot2c_f32_bf16 v58, v163, v37
  v_dot2c_f32_bf16 v59, v163, v10
  v_lshlrev_b32 v9, 16, v38
  v_dot2c_f32_bf16 v52, v164, v38
  v_dot2c_f32_bf16 v53, v164, v9
  v_dot2c_f32_bf16 v54, v165, v38
  v_dot2c_f32_bf16 v55, v165, v9
  v_dot2c_f32_bf16 v56, v166, v38
  v_dot2c_f32_bf16 v57, v166, v9
  v_dot2c_f32_bf16 v58, v167, v38
  v_dot2c_f32_bf16 v59, v167, v9
  v_lshlrev_b32 v10, 16, v39
  v_dot2c_f32_bf16 v52, v168, v39
  v_dot2c_f32_bf16 v53, v168, v10
  v_dot2c_f32_bf16 v54, v169, v39
  v_dot2c_f32_bf16 v55, v169, v10
  v_dot2c_f32_bf16 v56, v170, v39
  v_dot2c_f32_bf16 v57, v170, v10
  v_dot2c_f32_bf16 v58, v171, v39
  v_dot2c_f32_bf16 v59, v171, v10
  v_lshlrev_b32 v9, 16, v40
  v_dot2c_f32_bf16 v52, v172, v40
  v_dot2c_f32_bf16 v53, v172, v9
  v_dot2c_f32_bf16 v54, v173, v40
  v_dot2c_f32_bf16 v55, v173, v9
  v_dot2c_f32_bf16 v56, v174, v40
  v_dot2c_f32_bf16 v57, v174, v9
  v_dot2c_f32_bf16 v58, v175, v40
  v_dot2c_f32_bf16 v59, v175, v9
  v_lshlrev_b32 v10, 16, v41
  v_dot2c_f32_bf16 v52, v176, v41
  v_dot2c_f32_bf16 v53, v176, v10
  v_dot2c_f32_bf16 v54, v177, v41
  v_dot2c_f32_bf16 v55, v177, v10
  v_dot2c_f32_bf16 v56, v178, v41
  v_dot2c_f32_bf16 v57, v178, v10
  v_dot2c_f32_bf16 v58, v179, v41
  v_dot2c_f32_bf16 v59, v179, v10
  v_lshlrev_b32 v9, 16, v42
  v_dot2c_f32_bf16 v52, v180, v42
  v_dot2c_f32_bf16 v53, v180, v9
  v_dot2c_f32_bf16 v54, v181, v42
  v_dot2c_f32_bf16 v55, v181, v9
  v_dot2c_f32_bf16 v56, v182, v42
  v_dot2c_f32_bf16 v57, v182, v9
  v_dot2c_f32_bf16 v58, v183, v42
  v_dot2c_f32_bf16 v59, v183, v9
  v_lshlrev_b32 v10, 16, v43
  v_dot2c_f32_bf16 v52, v184, v43
  v_dot2c_f32_bf16 v53, v184, v10
  v_dot2c_f32_bf16 v54, v185, v43
  v_dot2c_f32_bf16 v55, v185, v10
  v_dot2c_f32_bf16 v56, v186, v43
  v_dot2c_f32_bf16 v57, v186, v10
  v_dot2c_f32_bf16 v58, v187, v43
  v_dot2c_f32_bf16 v59, v187, v10
  v_lshlrev_b32 v9, 16, v44
  v_dot2c_f32_bf16 v52, v188, v44
  v_dot2c_f32_bf16 v53, v188, v9
  v_dot2c_f32_bf16 v54, v189, v44
  v_dot2c_f32_bf16 v55, v189, v9
  v_dot2c_f32_bf16 v56, v190, v44
  v_dot2c_f32_bf16 v57, v190, v9
  v_dot2c_f32_bf16 v58, v191, v44
  v_dot2c_f32_bf16 v59, v191, v9
  v_lshlrev_b32 v10, 16, v45
  v_dot2c_f32_bf16 v52, v192, v45
  v_dot2c_f32_bf16 v53, v192, v10
  v_dot2c_f32_bf16 v54, v193, v45
  v_dot2c_f32_bf16 v55, v193, v10
  v_dot2c_f32_bf16 v56, v194, v45
  v_dot2c_f32_bf16 v57, v194, v10
  v_dot2c_f32_bf16 v58, v195, v45
  v_dot2c_f32_bf16 v59, v195, v10
  v_lshlrev_b32 v9, 16, v46
  v_dot2c_f32_bf16 v52, v196, v46
  v_dot2c_f32_bf16 v53, v196, v9
  v_dot2c_f32_bf16 v54, v197, v46
  v_dot2c_f32_bf16 v55, v197, v9
  v_dot2c_f32_bf16 v56, v198, v46
  v_dot2c_f32_bf16 v57, v198, v9
  v_dot2c_f32_bf16 v58, v199, v46
  v_dot2c_f32_bf16 v59, v199, v9
  v_lshlrev_b32 v10, 16, v47
  v_dot2c_f32_bf16 v52, v200, v47
  v_dot2c_f32_bf16 v53, v200, v10
  v_dot2c_f32_bf16 v54, v201, v47
  v_dot2c_f32_bf16 v55, v201, v10
  v_dot2c_f32_bf16 v56, v202, v47
  v_dot2c_f32_bf16 v57, v202, v10
  v_dot2c_f32_bf16 v58, v203, v47
  v_dot2c_f32_bf16 v59, v203, v10
  ds_read_u16 v32, v7 offset:4672
  ds_read_u16 v33, v7 offset:4688
  ds_read_u16 v34, v7 offset:4704
  ds_read_u16 v35, v7 offset:4720
  ds_read_u16 v36, v7 offset:4736
  ds_read_u16 v37, v7 offset:4752
  ds_read_u16 v38, v7 offset:4768
  ds_read_u16 v39, v7 offset:4784
  ds_read_u16 v40, v7 offset:4800
  ds_read_u16 v41, v7 offset:4816
  ds_read_u16 v42, v7 offset:4832
  ds_read_u16 v43, v7 offset:4848
  ds_read_u16 v44, v7 offset:4864
  ds_read_u16 v45, v7 offset:4880
  ds_read_u16 v46, v7 offset:4896
  ds_read_u16 v47, v7 offset:4912
  s_waitcnt vmcnt(0) lgkmcnt(0)
  v_lshlrev_b32 v9, 16, v32
  v_dot2c_f32_bf16 v52, v76, v32
  v_dot2c_f32_bf16 v53, v76, v9
  v_dot2c_f32_bf16 v54, v77, v32
  v_dot2c_f32_bf16 v55, v77, v9
  v_dot2c_f32_bf16 v56, v78, v32
  v_dot2c_f32_bf16 v57, v78, v9
  v_dot2c_f32_bf16 v58, v79, v32
  v_dot2c_f32_bf16 v59, v79, v9
  v_lshlrev_b32 v10, 16, v33
  v_dot2c_f32_bf16 v52, v80, v33
  v_dot2c_f32_bf16 v53, v80, v10
  v_dot2c_f32_bf16 v54, v81, v33
  v_dot2c_f32_bf16 v55, v81, v10
  v_dot2c_f32_bf16 v56, v82, v33
  v_dot2c_f32_bf16 v57, v82, v10
  v_dot2c_f32_bf16 v58, v83, v33
  v_dot2c_f32_bf16 v59, v83, v10
  v_lshlrev_b32 v9, 16, v34
  v_dot2c_f32_bf16 v52, v84, v34
  v_dot2c_f32_bf16 v53, v84, v9
  v_dot2c_f32_bf16 v54, v85, v34
  v_dot2c_f32_bf16 v55, v85, v9
  v_dot2c_f32_bf16 v56, v86, v34
  v_dot2c_f32_bf16 v57, v86, v9
  v_dot2c_f32_bf16 v58, v87, v34
  v_dot2c_f32_bf16 v59, v87, v9
  v_lshlrev_b32 v10, 16, v35
  v_dot2c_f32_bf16 v52, v88, v35
  v_dot2c_f32_bf16 v53, v88, v10
  v_dot2c_f32_bf16 v54, v89, v35
  v_dot2c_f32_bf16 v55, v89, v10
  v_dot2c_f32_bf16 v56, v90, v35
  v_dot2c_f32_bf16 v57, v90, v10
  v_dot2c_f32_bf16 v58, v91, v35
  v_dot2c_f32_bf16 v59, v91, v10
  v_lshlrev_b32 v9, 16, v36
  v_dot2c_f32_bf16 v52, v92, v36
  v_dot2c_f32_bf16 v53, v92, v9
  v_dot2c_f32_bf16 v54, v93, v36
  v_dot2c_f32_bf16 v55, v93, v9
  v_dot2c_f32_bf16 v56, v94, v36
  v_dot2c_f32_bf16 v57, v94, v9
  v_dot2c_f32_bf16 v58, v95, v36
  v_dot2c_f32_bf16 v59, v95, v9
  v_lshlrev_b32 v10, 16, v37
  v_dot2c_f32_bf16 v52, v96, v37
  v_dot2c_f32_bf16 v53, v96, v10
  v_dot2c_f32_bf16 v54, v97, v37
  v_dot2c_f32_bf16 v55, v97, v10
  v_dot2c_f32_bf16 v56, v98, v37
  v_dot2c_f32_bf16 v57, v98, v10
  v_dot2c_f32_bf16 v58, v99, v37
  v_dot2c_f32_bf16 v59, v99, v10
  v_lshlrev_b32 v9, 16, v38
  v_dot2c_f32_bf16 v52, v100, v38
  v_dot2c_f32_bf16 v53, v100, v9
  v_dot2c_f32_bf16 v54, v101, v38
  v_dot2c_f32_bf16 v55, v101, v9
  v_dot2c_f32_bf16 v56, v102, v38
  v_dot2c_f32_bf16 v57, v102, v9
  v_dot2c_f32_bf16 v58, v103, v38
  v_dot2c_f32_bf16 v59, v103, v9
  v_lshlrev_b32 v10, 16, v39
  v_dot2c_f32_bf16 v52, v104, v39
  v_dot2c_f32_bf16 v53, v104, v10
  v_dot2c_f32_bf16 v54, v105, v39
  v_dot2c_f32_bf16 v55, v105, v10
  v_dot2c_f32_bf16 v56, v106, v39
  v_dot2c_f32_bf16 v57, v106, v10
  v_dot2c_f32_bf16 v58, v107, v39
  v_dot2c_f32_bf16 v59, v107, v10
  v_lshlrev_b32 v9, 16, v40
  v_dot2c_f32_bf16 v52, v108, v40
  v_dot2c_f32_bf16 v53, v108, v9
  v_dot2c_f32_bf16 v54, v109, v40
  v_dot2c_f32_bf16 v55, v109, v9
  v_dot2c_f32_bf16 v56, v110, v40
  v_dot2c_f32_bf16 v57, v110, v9
  v_dot2c_f32_bf16 v58, v111, v40
  v_dot2c_f32_bf16 v59, v111, v9
  v_lshlrev_b32 v10, 16, v41
  v_dot2c_f32_bf16 v52, v112, v41
  v_dot2c_f32_bf16 v53, v112, v10
  v_dot2c_f32_bf16 v54, v113, v41
  v_dot2c_f32_bf16 v55, v113, v10
  v_dot2c_f32_bf16 v56, v114, v41
  v_dot2c_f32_bf16 v57, v114, v10
  v_dot2c_f32_bf16 v58, v115, v41
  v_dot2c_f32_bf16 v59, v115, v10
  v_lshlrev_b32 v9, 16, v42
  v_dot2c_f32_bf16 v52, v116, v42
  v_dot2c_f32_bf16 v53, v116, v9
  v_dot2c_f32_bf16 v54, v117, v42
  v_dot2c_f32_bf16 v55, v117, v9
  v_dot2c_f32_bf16 v56, v118, v42
  v_dot2c_f32_bf16 v57, v118, v9
  v_dot2c_f32_bf16 v58, v119, v42
  v_dot2c_f32_bf16 v59, v119, v9
  v_lshlrev_b32 v10, 16, v43
  v_dot2c_f32_bf16 v52, v120, v43
  v_dot2c_f32_bf16 v53, v120, v10
  v_dot2c_f32_bf16 v54, v121, v43
  v_dot2c_f32_bf16 v55, v121, v10
  v_dot2c_f32_bf16 v56, v122, v43
  v_dot2c_f32_bf16 v57, v122, v10
  v_dot2c_f32_bf16 v58, v123, v43
  v_dot2c_f32_bf16 v59, v123, v10
  v_lshlrev_b32 v9, 16, v44
  v_dot2c_f32_bf16 v52, v124, v44
  v_dot2c_f32_bf16 v53, v124, v9
  v_dot2c_f32_bf16 v54, v125, v44
  v_dot2c_f32_bf16 v55, v125, v9
  v_dot2c_f32_bf16 v56, v126, v44
  v_dot2c_f32_bf16 v57, v126, v9
  v_dot2c_f32_bf16 v58, v127, v44
  v_dot2c_f32_bf16 v59, v127, v9
  v_lshlrev_b32 v10, 16, v45
  v_dot2c_f32_bf16 v52, v128, v45
  v_dot2c_f32_bf16 v53, v128, v10
  v_dot2c_f32_bf16 v54, v129, v45
  v_dot2c_f32_bf16 v55, v129, v10
  v_dot2c_f32_bf16 v56, v130, v45
  v_dot2c_f32_bf16 v57, v130, v10
  v_dot2c_f32_bf16 v58, v131, v45
  v_dot2c_f32_bf16 v59, v131, v10
  v_lshlrev_b32 v9, 16, v46
  v_dot2c_f32_bf16 v52, v132, v46
  v_dot2c_f32_bf16 v53, v132, v9
  v_dot2c_f32_bf16 v54, v133, v46
  v_dot2c_f32_bf16 v55, v133, v9
  v_dot2c_f32_bf16 v56, v134, v46
  v_dot2c_f32_bf16 v57, v134, v9
  v_dot2c_f32_bf16 v58, v135, v46
  v_dot2c_f32_bf16 v59, v135, v9
  v_lshlrev_b32 v10, 16, v47
  v_dot2c_f32_bf16 v52, v136, v47
  v_dot2c_f32_bf16 v53, v136, v10
  v_dot2c_f32_bf16 v54, v137, v47
  v_dot2c_f32_bf16 v55, v137, v10
  v_dot2c_f32_bf16 v56, v138, v47
  v_dot2c_f32_bf16 v57, v138, v10
  v_dot2c_f32_bf16 v58, v139, v47
  v_dot2c_f32_bf16 v59, v139, v10
  v_permlane32_swap_b32 v52, v56
  v_permlane32_swap_b32 v53, v57
  v_permlane32_swap_b32 v54, v58
  v_permlane32_swap_b32 v55, v59
  v_add_f32 v52, v52, v56
  v_add_f32 v53, v53, v57
  v_add_f32 v54, v54, v58
  v_add_f32 v55, v55, v59
  s_nop 0
  v_permlane16_swap_b32 v52, v54
  v_permlane16_swap_b32 v53, v55
  v_add_f32 v52, v52, v54
  v_add_f32 v53, v53, v55
  s_nop 0
  v_add_f32_dpp v52, v52, v52 row_ror:8 row_mask:0xf bank_mask:0xf
  v_add_f32_dpp v53, v53, v53 row_ror:8 row_mask:0xf bank_mask:0xf
  v_cndmask_b32 v52, v52, v53, s[60:61]
  s_lshl_b32 s62, s3, 8
  v_add_u32 v6, s62, v19
  ds_write_b32 v6, v52 offset:7232
  s_mov_b64 exec, 1
  ds_add_u32 v21, v20 offset:32
  s_mov_b64 exec, -1
  s_cmp_lg_u32 s3, 3
  s_cbranch_scc1 L_Hjoin_22
  s_mov_b32 s64, 262144
L_cw_31:
  ds_read_b32 v5, v21 offset:32
  s_waitcnt lgkmcnt(0)
  v_readfirstlane_b32 s62, v5
  s_cmp_ge_u32 s62, 4
  s_cbranch_scc1 L_cw_done_32
  s_sub_u32 s64, s64, 1
  s_cbranch_scc1 L_cw_done_32
  s_branch L_cw_31
L_cw_done_32:
  ds_read_b32 v52, v1 offset:7232
  ds_read_b32 v53, v1 offset:7488
  ds_read_b32 v54, v1 offset:7744
  ds_read_b32 v55, v1 offset:8000
  s_waitcnt lgkmcnt(0)
  v_add_f32 v52, v52, v53
  v_add_f32 v54, v54, v55
  v_add_f32 v52, v52, v54
  v_cvt_pk_bf16_f32 v52, 0, v52
  v_mov_b32 v53, s65
  s_lshl_b32 s62, s97, 9
  s_add_u32 s62, s62, 1835008
  buffer_store_dwordx2 v[52:53], v17, s[36:39], s62 offen sc1
L_Hjoin_22:
  v_lshlrev_b32 v225, 4, v0
  s_lshl_b32 s96, s15, 2
  s_add_u32 s96, s96, s3
  s_mul_i32 s97, s96, 11
  s_lshr_b32 s97, s97, 5
  s_mul_i32 s62, s97, 3
  s_sub_u32 s98, s96, s62
  s_cmp_lt_u32 s96, 30
  s_cselect_b32 s63, 7864320, 0
  s_mov_b32 s48, s12
  s_mov_b32 s49, s13
  s_mov_b32 s50, s63
  s_mov_b32 s51, 0x20000
  s_mov_b32 s56, s22
  s_mov_b32 s57, s23
  s_mov_b32 s58, 1280
  s_mov_b32 s59, 0x20000
  v_lshlrev_b32 v5, 4, v4
  s_movk_i32 s63, 1280
  v_mad_u32_u24 v220, v3, s63, v5
  v_lshlrev_b32 v221, 2, v3
  v_lshlrev_b32 v5, 3, v3
  s_movk_i32 s63, 6144
  v_mad_u32_u24 v222, v4, s63, v5
  s_mul_i32 s62, s14, 192
  s_lshl_b32 s63, s98, 6
  s_add_u32 s62, s62, s63
  s_mul_i32 s62, s62, 1280
  s_lshl_b32 s63, s97, 7
  s_add_u32 s62, s62, s63
  buffer_load_dwordx4 v[148:151], v220, s[48:51], s62 offen nt
  s_add_u32 s62, s62, 10240
  buffer_load_dwordx4 v[152:155], v220, s[48:51], s62 offen nt
  s_add_u32 s62, s62, 10240
  buffer_load_dwordx4 v[156:159], v220, s[48:51], s62 offen nt
  s_add_u32 s62, s62, 10240
  buffer_load_dwordx4 v[160:163], v220, s[48:51], s62 offen nt
  s_add_u32 s62, s62, 10240
  buffer_load_dwordx4 v[164:167], v220, s[48:51], s62 offen nt
  s_add_u32 s62, s62, 10240
  buffer_load_dwordx4 v[168:171], v220, s[48:51], s62 offen nt
  s_add_u32 s62, s62, 10240
  buffer_load_dwordx4 v[172:175], v220, s[48:51], s62 offen nt
  s_add_u32 s62, s62, 10240
  buffer_load_dwordx4 v[176:179], v220, s[48:51], s62 offen nt
  s_mul_i32 s68, s97, 768
  s_mul_i32 s62, s14, 3
  s_add_u32 s68, s68, s62
  s_add_u32 s68, s68, s98
  s_lshl_b32 s68, s68, 6
  s_add_u32 s68, s68, 1310720
  s_cmp_ge_u32 s100, 80
  s_cbranch_scc1 L_nored_33
  s_cmp_lg_u32 s3, 3
  s_cbranch_scc1 L_nored_33
  v_and_b32 v5, 3, v0
  v_lshlrev_b32 v5, 2, v5
  s_lshl_b32 s62, s100, 4
  buffer_load_dword v224, v5, s[28:31], s62 offen
  s_lshl_b32 s69, s100, 6
  s_add_u32 s69, s69, 1835008
  v_lshlrev_b32 v7, 2, v5
  s_mov_b32 s64, 65536
L_pollB_34:
  buffer_load_dwordx4 v[68:71], v7, s[36:39], s69 offen sc1
  s_waitcnt vmcnt(0)
  v_max_u32 v5, v69, v71
  v_min_u32 v6, v69, v71
  v_xor_b32 v5, s65, v5
  v_xor_b32 v6, s65, v6
  v_or_b32 v5, v5, v6
  v_cmp_ne_u32 vcc, 0, v5
  s_cbranch_vccz L_pollB_done_35
  s_sub_u32 s64, s64, 1
  s_cbranch_scc1 L_pollB_done_35
  s_sleep 8
  s_branch L_pollB_34
L_pollB_done_35:
  v_mov_b32 v226, v68
  v_mov_b32 v227, v70
L_nored_33:
  s_lshl_b32 s62, s3, 8
  v_add_u32 v22, s62, v1
  v_lshlrev_b32 v25, 1, v22
  s_lshl_b32 s62, s98, 9
  v_add_u32 v23, s62, v17
  v_and_b32 v5, 7, v0
  v_lshlrev_b32 v5, 11, v5
  v_add_u32 v24, 1536, v5
  s_cmp_lg_u32 s3, 2
  s_cbranch_scc1 L_noserve_36
  s_lshl_b32 s91, s14, 8
  s_add_u32 s91, s91, 0
  s_mov_b32 s64, 262144
L_wake_37:
  ds_read_b32 v5, v21 offset:20
  s_waitcnt lgkmcnt(0)
  v_readfirstlane_b32 s62, v5
  s_cmp_ge_u32 s62, 1
  s_cbranch_scc1 L_wake_done_38
  s_sub_u32 s64, s64, 1
  s_cbranch_scc1 L_wake_done_38
  s_sleep 8
  s_branch L_wake_37
L_wake_done_38:
  s_mov_b32 s64, 65536
L_armed_39:
  buffer_load_dwordx2 v[6:7], v18, s[36:39], s91 offen sc1
  s_waitcnt vmcnt(0)
  v_readfirstlane_b32 s89, v6
  v_readfirstlane_b32 s62, v7
  s_cmp_eq_u32 s62, s65
  s_cbranch_scc1 L_armed_done_40
  s_sub_u32 s64, s64, 1
  s_cbranch_scc1 L_armed_done_40
  s_sleep 8
  s_branch L_armed_39
L_armed_done_40:
  s_mov_b32 s88, 0
  s_mov_b32 s64, 262144
L_serve_41:
  ds_read_b32 v5, v21 offset:24
  s_waitcnt lgkmcnt(0)
  v_readfirstlane_b32 s62, v5
  s_sub_i32 s62, s88, s62
  s_cmp_lt_i32 s62, 4
  s_cbranch_scc1 L_claim_42
  s_sub_u32 s64, s64, 1
  s_cbranch_scc1 L_serve_done_43
  s_sleep 2
  s_branch L_serve_41
L_claim_42:
  s_sub_i32 s90, 800, s89
  s_max_i32 s90, s90, 0
  s_lshr_b32 s90, s90, 3
  s_max_u32 s90, s90, 2
  s_min_u32 s90, s90, 63
  v_mov_b32 v6, s90
  buffer_atomic_add v6, v18, s[36:39], s91 offen sc0
  v_add_u32 v7, s88, v0
  v_lshlrev_b32 v7, 2, v7
  s_waitcnt vmcnt(0)
  v_readfirstlane_b32 s62, v6
  s_nop 1
  v_add_u32 v8, s62, v0
  s_bfm_b64 exec, s90, 0
  ds_write_b32 v7, v8 offset:8256
  s_mov_b64 exec, -1
  s_add_u32 s88, s88, s90
  s_mul_i32 s89, s90, 8
  s_add_u32 s89, s89, s62
  s_add_u32 s62, s62, s90
  s_cmp_lt_u32 s62, 800
  s_cbranch_scc1 L_serve_41
L_serve_done_43:
  v_add_u32 v7, s88, v0
  v_lshlrev_b32 v7, 2, v7
  v_mov_b32 v8, 800
  ds_write_b32 v7, v8 offset:8256
  s_waitcnt lgkmcnt(0)
L_noserve_36:
  s_mov_b32 s6, 0
  s_mov_b32 s7, s67
  s_mov_b32 s8, s68
  s_lshl_b32 s9, s100, 4
  s_mov_b32 s16, 65536
L_pass:
  s_lshl_b32 s69, s14, 14
  s_add_u32 s69, s69, 786432
  s_add_u32 s89, s69, 4096
  s_add_u32 s90, s69, 8192
  s_add_u32 s91, s69, 12288
  s_waitcnt vmcnt(0)
  s_mov_b32 s62, 0x05040100
  s_mov_b32 s63, 0x07060302
  v_perm_b32 v5, v152, v148, s62
  v_perm_b32 v152, v152, v148, s63
  v_mov_b32 v148, v5
  v_perm_b32 v5, v153, v149, s62
  v_perm_b32 v153, v153, v149, s63
  v_mov_b32 v149, v5
  v_perm_b32 v5, v154, v150, s62
  v_perm_b32 v154, v154, v150, s63
  v_mov_b32 v150, v5
  v_perm_b32 v5, v155, v151, s62
  v_perm_b32 v155, v155, v151, s63
  v_mov_b32 v151, v5
  v_perm_b32 v5, v160, v156, s62
  v_perm_b32 v160, v160, v156, s63
  v_mov_b32 v156, v5
  v_perm_b32 v5, v161, v157, s62
  v_perm_b32 v161, v161, v157, s63
  v_mov_b32 v157, v5
  v_perm_b32 v5, v162, v158, s62
  v_perm_b32 v162, v162, v158, s63
  v_mov_b32 v158, v5
  v_perm_b32 v5, v163, v159, s62
  v_perm_b32 v163, v163, v159, s63
  v_mov_b32 v159, v5
  v_perm_b32 v5, v168, v164, s62
  v_perm_b32 v168, v168, v164, s63
  v_mov_b32 v164, v5
  v_perm_b32 v5, v169, v165, s62
  v_perm_b32 v169, v169, v165, s63
  v_mov_b32 v165, v5
  v_perm_b32 v5, v170, v166, s62
  v_perm_b32 v170, v170, v166, s63
  v_mov_b32 v166, v5
  v_perm_b32 v5, v171, v167, s62
  v_perm_b32 v171, v171, v167, s63
  v_mov_b32 v167, v5
  v_perm_b32 v5, v176, v172, s62
  v_perm_b32 v176, v176, v172, s63
  v_mov_b32 v172, v5
  v_perm_b32 v5, v177, v173, s62
  v_perm_b32 v177, v177, v173, s63
  v_mov_b32 v173, v5
  v_perm_b32 v5, v178, v174, s62
  v_perm_b32 v178, v178, v174, s63
  v_mov_b32 v174, v5
  v_perm_b32 v5, v179, v175, s62
  v_perm_b32 v179, v179, v175, s63
  v_mov_b32 v175, v5
  s_barrier
  v_mov_b32 v5, 0
  ds_read_b32 v72, v5 offset:768
  ds_read_b32 v73, v5 offset:1568
  ds_read_b32 v74, v5 offset:2368
  ds_read_b32 v75, v5 offset:3168
  ds_read_b32 v68, v22 offset:0
  ds_read_b32 v69, v22 offset:800
  ds_read_b32 v70, v22 offset:1600
  ds_read_b32 v71, v22 offset:2400
  s_waitcnt lgkmcnt(4)
  v_max_f32 v6, v72, v73
  v_max3_f32 v6, v74, v75, v6
  v_sub_f32 v72, v72, v6
  v_sub_f32 v73, v73, v6
  v_sub_f32 v74, v74, v6
  v_sub_f32 v75, v75, v6
  v_mul_f32 v72, 0x3fb8aa3b, v72
  v_mul_f32 v73, 0x3fb8aa3b, v73
  v_mul_f32 v74, 0x3fb8aa3b, v74
  v_mul_f32 v75, 0x3fb8aa3b, v75
  v_exp_f32 v72, v72
  v_exp_f32 v73, v73
  v_exp_f32 v74, v74
  v_exp_f32 v75, v75
  s_waitcnt lgkmcnt(0)
  v_mul_f32 v68, v68, v72
  v_fmac_f32 v68, v69, v73
  v_fmac_f32 v68, v70, v74
  v_fmac_f32 v68, v71, v75
  v_cmp_eq_u32 vcc, 768, v22
  s_nop 1
  v_cndmask_b32 v68, v68, v6, vcc
  v_mov_b32 v69, s65
  buffer_store_dwordx2 v[68:69], v25, s[36:39], s7 offen sc1
  s_waitcnt vmcnt(0)
  s_cmp_ge_u32 s96, 30
  s_cbranch_scc1 L_reducer_44
  s_mov_b32 s64, s16
L_hop1_45:
  buffer_load_dwordx4 v[92:95], v24, s[36:39], s69 offen sc1
  buffer_load_dwordx2 v[76:77], v23, s[36:39], s69 offen offset:0 sc1
  buffer_load_dwordx2 v[78:79], v23, s[36:39], s69 offen offset:2048 sc1
  buffer_load_dwordx2 v[80:81], v23, s[36:39], s89 offen offset:0 sc1
  buffer_load_dwordx2 v[82:83], v23, s[36:39], s89 offen offset:2048 sc1
  buffer_load_dwordx2 v[84:85], v23, s[36:39], s90 offen offset:0 sc1
  buffer_load_dwordx2 v[86:87], v23, s[36:39], s90 offen offset:2048 sc1
  buffer_load_dwordx2 v[88:89], v23, s[36:39], s91 offen offset:0 sc1
  buffer_load_dwordx2 v[90:91], v23, s[36:39], s91 offen offset:2048 sc1
  s_waitcnt vmcnt(0)
  v_max3_u32 v5, v93, v95, v77
  v_max3_u32 v5, v5, v79, v81
  v_max3_u32 v5, v5, v83, v85
  v_max3_u32 v5, v5, v87, v89
  v_max_u32 v5, v5, v91
  v_min3_u32 v6, v93, v95, v77
  v_min3_u32 v6, v6, v79, v81
  v_min3_u32 v6, v6, v83, v85
  v_min3_u32 v6, v6, v87, v89
  v_min_u32 v6, v6, v91
  v_xor_b32 v5, s65, v5
  v_xor_b32 v6, s65, v6
  v_or_b32 v5, v5, v6
  v_cmp_ne_u32 vcc, 0, v5
  s_cbranch_vccz L_hop1_done_46
  s_sub_u32 s64, s64, 1
  s_cbranch_scc1 L_hop1_done_46
  s_branch L_hop1_45
L_hop1_done_46:
  v_max_f32_dpp v6, v92, v92 quad_perm:[1,0,3,2] row_mask:0xf bank_mask:0xf
  s_nop 1
  v_max_f32_dpp v6, v6, v6 quad_perm:[2,3,0,1] row_mask:0xf bank_mask:0xf
  s_nop 1
  v_max_f32_dpp v6, v6, v6 row_half_mirror row_mask:0xf bank_mask:0xf
  v_sub_f32 v96, v92, v6
  v_mul_f32 v96, 0x3fb8aa3b, v96
  v_exp_f32 v96, v96
  s_nop 0
  v_mul_f32 v6, v96, v94
  s_nop 1
  v_add_f32_dpp v6, v6, v6 quad_perm:[1,0,3,2] row_mask:0xf bank_mask:0xf
  s_nop 1
  v_add_f32_dpp v6, v6, v6 quad_perm:[2,3,0,1] row_mask:0xf bank_mask:0xf
  s_nop 1
  v_add_f32_dpp v6, v6, v6 row_half_mirror row_mask:0xf bank_mask:0xf
  v_rcp_f32 v6, v6
  s_nop 0
  v_mul_f32 v96, v96, v6
  s_nop 0
  v_readlane_b32 s88, v96, 0
  v_readlane_b32 s89, v96, 1
  v_readlane_b32 s90, v96, 2
  v_readlane_b32 s91, v96, 3
  v_readlane_b32 s92, v96, 4
  v_readlane_b32 s93, v96, 5
  v_readlane_b32 s94, v96, 6
  v_readlane_b32 s95, v96, 7
  v_mul_f32 v97, s88, v76
  v_fmac_f32 v97, s89, v78
  v_fmac_f32 v97, s90, v80
  v_fmac_f32 v97, s91, v82
  v_fmac_f32 v97, s92, v84
  v_fmac_f32 v97, s93, v86
  v_fmac_f32 v97, s94, v88
  v_fmac_f32 v97, s95, v90
  s_nop 1
  v_mov_b32_dpp v96, v97 row_ror:8 row_mask:0xf bank_mask:0xf
  v_cvt_pk_bf16_f32 v97, v97, v96
  ds_bpermute_b32 v32, v221, v97 offset:0
  ds_bpermute_b32 v33, v221, v97 offset:64
  ds_bpermute_b32 v34, v221, v97 offset:128
  ds_bpermute_b32 v35, v221, v97 offset:192
  v_mov_b32 v212, 0
  v_mov_b32 v213, 0
  v_mov_b32 v214, 0
  v_mov_b32 v215, 0
  v_mov_b32 v216, 0
  v_mov_b32 v217, 0
  v_mov_b32 v218, 0
  v_mov_b32 v219, 0
  s_waitcnt lgkmcnt(3)
  v_dot2c_f32_bf16 v212, v148, v32
  v_dot2c_f32_bf16 v213, v152, v32
  v_dot2c_f32_bf16 v214, v149, v32
  v_dot2c_f32_bf16 v215, v153, v32
  v_dot2c_f32_bf16 v216, v150, v32
  v_dot2c_f32_bf16 v217, v154, v32
  v_dot2c_f32_bf16 v218, v151, v32
  v_dot2c_f32_bf16 v219, v155, v32
  s_waitcnt lgkmcnt(2)
  v_dot2c_f32_bf16 v212, v156, v33
  v_dot2c_f32_bf16 v213, v160, v33
  v_dot2c_f32_bf16 v214, v157, v33
  v_dot2c_f32_bf16 v215, v161, v33
  v_dot2c_f32_bf16 v216, v158, v33
  v_dot2c_f32_bf16 v217, v162, v33
  v_dot2c_f32_bf16 v218, v159, v33
  v_dot2c_f32_bf16 v219, v163, v33
  s_waitcnt lgkmcnt(1)
  v_dot2c_f32_bf16 v212, v164, v34
  v_dot2c_f32_bf16 v213, v168, v34
  v_dot2c_f32_bf16 v214, v165, v34
  v_dot2c_f32_bf16 v215, v169, v34
  v_dot2c_f32_bf16 v216, v166, v34
  v_dot2c_f32_bf16 v217, v170, v34
  v_dot2c_f32_bf16 v218, v167, v34
  v_dot2c_f32_bf16 v219, v171, v34
  s_waitcnt lgkmcnt(0)
  v_dot2c_f32_bf16 v212, v172, v35
  v_dot2c_f32_bf16 v213, v176, v35
  v_dot2c_f32_bf16 v214, v173, v35
  v_dot2c_f32_bf16 v215, v177, v35
  v_dot2c_f32_bf16 v216, v174, v35
  v_dot2c_f32_bf16 v217, v178, v35
  v_dot2c_f32_bf16 v218, v175, v35
  v_dot2c_f32_bf16 v219, v179, v35
  v_permlane32_swap_b32 v212, v216
  v_permlane32_swap_b32 v213, v217
  v_permlane32_swap_b32 v214, v218
  v_permlane32_swap_b32 v215, v219
  v_add_f32 v212, v212, v216
  v_add_f32 v213, v213, v217
  v_add_f32 v214, v214, v218
  v_add_f32 v215, v215, v219
  s_nop 0
  v_permlane16_swap_b32 v212, v214
  v_permlane16_swap_b32 v213, v215
  v_add_f32 v212, v212, v214
  v_add_f32 v213, v213, v215
  s_nop 0
  v_add_f32_dpp v212, v212, v212 row_ror:8 row_mask:0xf bank_mask:0xf
  v_add_f32_dpp v213, v213, v213 row_ror:8 row_mask:0xf bank_mask:0xf
  v_cndmask_b32 v212, v212, v213, s[60:61]
  v_mov_b32 v213, s65
  buffer_store_dwordx2 v[212:213], v222, s[36:39], s8 offen sc1
  s_waitcnt vmcnt(0)
L_reducer_44:
  s_cmp_ge_u32 s100, 80
  s_cbranch_scc1 L_fin_47
  s_cmp_lg_u32 s3, 3
  s_cbranch_scc1 L_fin_47
  s_mul_i32 s69, s100, 6144
  s_add_u32 s69, s69, 1310720
  s_add_u32 s62, s69, 4096
  s_mov_b32 s64, s16
L_hop2_48:
  buffer_load_dwordx4 v[100:103], v225, s[36:39], s69 offen offset:0 sc1
  buffer_load_dwordx4 v[104:107], v225, s[36:39], s69 offen offset:1024 sc1
  buffer_load_dwordx4 v[108:111], v225, s[36:39], s69 offen offset:2048 sc1
  buffer_load_dwordx4 v[112:115], v225, s[36:39], s69 offen offset:3072 sc1
  buffer_load_dwordx4 v[116:119], v225, s[36:39], s62 offen offset:0 sc1
  buffer_load_dwordx4 v[120:123], v225, s[36:39], s62 offen offset:1024 sc1
  s_waitcnt vmcnt(0)
  v_max3_u32 v5, v101, v103, v105
  v_max3_u32 v5, v5, v107, v109
  v_max3_u32 v5, v5, v111, v113
  v_max3_u32 v5, v5, v115, v117
  v_max3_u32 v5, v5, v119, v121
  v_max_u32 v5, v5, v123
  v_min3_u32 v6, v101, v103, v105
  v_min3_u32 v6, v6, v107, v109
  v_min3_u32 v6, v6, v111, v113
  v_min3_u32 v6, v6, v115, v117
  v_min3_u32 v6, v6, v119, v121
  v_min_u32 v6, v6, v123
  v_xor_b32 v5, s65, v5
  v_xor_b32 v6, s65, v6
  v_or_b32 v5, v5, v6
  v_cmp_ne_u32 vcc, 0, v5
  s_cbranch_vccz L_hop2_done_49
  s_sub_u32 s64, s64, 1
  s_cbranch_scc1 L_hop2_done_49
  s_branch L_hop2_48
L_hop2_done_49:
  v_add_f32 v124, v100, v104
  v_add_f32 v128, v108, v112
  v_add_f32 v130, v116, v120
  v_add_f32 v126, v102, v106
  v_add_f32 v129, v110, v114
  v_add_f32 v131, v118, v122
  v_add_f32 v124, v124, v128
  v_add_f32 v126, v126, v129
  v_add_f32 v124, v124, v130
  v_add_f32 v126, v126, v131
  s_nop 0
  v_add_f32_dpp v124, v124, v124 row_ror:4 row_mask:0xf bank_mask:0xf
  v_add_f32_dpp v126, v126, v126 row_ror:4 row_mask:0xf bank_mask:0xf
  s_nop 0
  v_add_f32_dpp v124, v124, v124 row_ror:8 row_mask:0xf bank_mask:0xf
  v_add_f32_dpp v126, v126, v126 row_ror:8 row_mask:0xf bank_mask:0xf
  v_mov_b32 v125, v124
  v_mov_b32 v127, v126
  s_nop 0
  v_permlane16_swap_b32 v124, v125
  v_permlane16_swap_b32 v126, v127
  v_add_f32 v124, v124, v125
  v_add_f32 v126, v126, v127
  v_mov_b32 v125, v124
  v_mov_b32 v127, v126
  s_nop 0
  v_permlane32_swap_b32 v124, v125
  v_permlane32_swap_b32 v126, v127
  v_add_f32 v124, v124, v125
  v_add_f32 v126, v126, v127
  v_lshlrev_b32 v128, 16, v224
  v_and_b32 v129, 0xffff0000, v224
  v_cvt_pk_bf16_f32 v124, 0, v124
  v_cvt_pk_bf16_f32 v126, 0, v126
  v_add_f32 v128, v128, v124
  v_add_f32 v129, v129, v126
  v_cvt_pk_bf16_f32 v128, 0, v128
  v_cvt_pk_bf16_f32 v129, 0, v129
  v_add_f32 v128, v128, v226
  v_add_f32 v129, v129, v227
  v_cvt_pk_bf16_f32 v128, v128, v129
  s_mov_b64 exec, 15
  buffer_store_dword v128, v1, s[56:59], s9 offen sc0 sc1
  s_mov_b64 exec, -1
L_fin_47:
  s_endpgm
L_S:
  v_lshrrev_b32 v4, 3, v0
  v_and_b32 v5, 7, v0
  v_mul_u32_u24 v1, 384, v4
  v_lshl_add_u32 v1, v5, 4, v1
  v_mov_b32 v10, 1073741824
  v_cmp_ne_u32 vcc, 0, v0
  v_mov_b32 v9, 0
  s_nop 0
  v_cndmask_b32 v9, v9, v10, vcc
  v_mov_b32 v2, 0xff61b1e6
  v_mov_b32 v3, 0
  v_mov_b32 v15, 4096
  v_mov_b32 v16, 1
  s_sub_u32 s44, s3, 4
  s_mul_i32 s44, s44, 27136
  s_add_u32 s44, s44, 12352
  v_lshlrev_b32 v11, 2, v0
  v_add_u32 v11, s44, v11
  v_mov_b32 v12, v11
  s_mov_b32 s48, 0xff00ff00
  s_mov_b32 s49, 0xff00ff00
  s_mov_b32 s54, 0x3d93cd3a
  s_mov_b32 s55, 0x3fb8aa3b
  s_mul_i32 s44, s14, 12582912
  s_mov_b32 s66, 0
  s_mul_i32 s68, s15, 104
  s_cmp_eq_u32 s15, 6
  s_cselect_b32 s66, -4, s66
  s_cmp_eq_u32 s15, 7
  s_cselect_b32 s45, 8, 0
  s_sub_u32 s68, s68, s45
  s_lshr_b32 s45, s14, 1
  s_cmp_eq_u32 s45, 12
  s_cbranch_scc1 L_special_50
  s_cmp_eq_u32 s15, 7
  s_cselect_b32 s66, 0, s66
  s_branch L_tsdone_51
L_special_50:
  s_min_u32 s45, s15, 4
  s_mul_i32 s45, s45, 2
  s_add_u32 s68, s68, s45
  s_cmp_lt_u32 s15, 4
  s_cselect_b32 s66, 1, s66
  s_cmp_eq_u32 s15, 7
  s_cselect_b32 s66, -4, s66
L_tsdone_51:
  s_mul_i32 s67, s66, 2
  s_add_u32 s67, s67, 104
  s_sub_u32 s40, s3, 4
  s_mul_i32 s40, s40, s67
  s_lshl_b32 s68, s68, 2
  s_add_u32 s40, s40, s68
  s_mul_i32 s40, s40, 3072
  s_add_u32 s40, s40, s44
  s_mov_b32 s42, s40
  s_add_u32 s41, s44, 10125312
  s_waitcnt lgkmcnt(0)
  s_cmp_lg_u32 s2, 0
  s_cbranch_scc1 L_nolead_52
  s_cmp_lg_u32 s3, 4
  s_cbranch_scc1 L_nolead_52
  s_mov_b32 s56, s24
  s_mov_b32 s57, s25
  s_mov_b32 s58, 256
  s_mov_b32 s59, 0x20000
  s_or_b32 s44, s70, 1
  v_mov_b32 v10, s44
  buffer_store_dword v10, v9, s[56:59], 0 offen sc1
L_nolead_52:
  s_barrier
  s_mov_b32 s28, s6
  s_mov_b32 s29, s7
  s_mov_b32 s30, 402653184
  s_mov_b32 s31, 0x20000
  s_mov_b32 s32, s8
  s_mov_b32 s33, s9
  s_mov_b32 s34, 402653184
  s_mov_b32 s35, 0x20000
  buffer_load_dwordx4 v[80:83], v1, s[28:31], s40 offen offset:0 nt
  buffer_load_dwordx4 v[84:87], v1, s[28:31], s40 offen offset:128 nt
  buffer_load_dwordx4 v[88:91], v1, s[28:31], s40 offen offset:256 nt
  s_add_u32 s40, s40, 3072
  buffer_load_dwordx4 v[92:95], v1, s[28:31], s40 offen offset:0 nt
  buffer_load_dwordx4 v[96:99], v1, s[28:31], s40 offen offset:128 nt
  buffer_load_dwordx4 v[100:103], v1, s[28:31], s40 offen offset:256 nt
  s_add_u32 s40, s40, 3072
  v_mov_b32 v10, 4096
  s_mov_b32 s46, 262144
L_pollgo_53:
  ds_read_b32 v4, v10 offset:16
  s_waitcnt lgkmcnt(0)
  v_readfirstlane_b32 s44, v4
  s_cmp_ge_u32 s44, 3
  s_cbranch_scc1 L_pollgo_done_54
  s_sub_u32 s46, s46, 1
  s_cbranch_scc1 L_pollgo_done_54
  s_sleep 1
  s_branch L_pollgo_53
L_pollgo_done_54:
  buffer_load_dwordx4 v[104:107], v1, s[28:31], s40 offen offset:0 nt
  buffer_load_dwordx4 v[108:111], v1, s[28:31], s40 offen offset:128 nt
  buffer_load_dwordx4 v[112:115], v1, s[28:31], s40 offen offset:256 nt
  s_add_u32 s40, s40, 3072
  buffer_load_dwordx4 v[116:119], v1, s[28:31], s40 offen offset:0 nt
  buffer_load_dwordx4 v[120:123], v1, s[28:31], s40 offen offset:128 nt
  buffer_load_dwordx4 v[124:127], v1, s[28:31], s40 offen offset:256 nt
  s_add_u32 s40, s40, 3072
  s_waitcnt vmcnt(9)
  buffer_load_dwordx4 v[128:131], v1, s[28:31], s40 offen offset:0 nt
  buffer_load_dwordx4 v[132:135], v1, s[28:31], s40 offen offset:128 nt
  buffer_load_dwordx4 v[136:139], v1, s[28:31], s40 offen offset:256 nt
  s_add_u32 s40, s40, 3072
  s_waitcnt vmcnt(9)
  buffer_load_dwordx4 v[140:143], v1, s[28:31], s40 offen offset:0 nt
  buffer_load_dwordx4 v[144:147], v1, s[28:31], s40 offen offset:128 nt
  buffer_load_dwordx4 v[148:151], v1, s[28:31], s40 offen offset:256 nt
  s_add_u32 s40, s40, 3072
  s_waitcnt vmcnt(9)
  buffer_load_dwordx4 v[152:155], v1, s[28:31], s40 offen offset:0 nt
  buffer_load_dwordx4 v[156:159], v1, s[28:31], s40 offen offset:128 nt
  buffer_load_dwordx4 v[160:163], v1, s[28:31], s40 offen offset:256 nt
  s_add_u32 s40, s40, 3072
  s_waitcnt vmcnt(9)
  buffer_load_dwordx4 v[164:167], v1, s[28:31], s40 offen offset:0 nt
  buffer_load_dwordx4 v[168:171], v1, s[28:31], s40 offen offset:128 nt
  buffer_load_dwordx4 v[172:175], v1, s[28:31], s40 offen offset:256 nt
  s_add_u32 s40, s40, 3072
  s_waitcnt vmcnt(9)
  buffer_load_dwordx4 v[176:179], v1, s[28:31], s40 offen offset:0 nt
  buffer_load_dwordx4 v[180:183], v1, s[28:31], s40 offen offset:128 nt
  buffer_load_dwordx4 v[184:187], v1, s[28:31], s40 offen offset:256 nt
  s_add_u32 s40, s40, 3072
  s_waitcnt vmcnt(9)
  buffer_load_dwordx4 v[188:191], v1, s[28:31], s40 offen offset:0 nt
  buffer_load_dwordx4 v[192:195], v1, s[28:31], s40 offen offset:128 nt
  buffer_load_dwordx4 v[196:199], v1, s[28:31], s40 offen offset:256 nt
  s_add_u32 s40, s40, 3072
  s_waitcnt vmcnt(9)
  buffer_load_dwordx4 v[200:203], v1, s[28:31], s40 offen offset:0 nt
  buffer_load_dwordx4 v[204:207], v1, s[28:31], s40 offen offset:128 nt
  buffer_load_dwordx4 v[208:211], v1, s[28:31], s40 offen offset:256 nt
  s_add_u32 s40, s40, 3072
  s_waitcnt vmcnt(9)
  buffer_load_dwordx4 v[212:215], v1, s[28:31], s40 offen offset:0 nt
  buffer_load_dwordx4 v[216:219], v1, s[28:31], s40 offen offset:128 nt
  buffer_load_dwordx4 v[220:223], v1, s[28:31], s40 offen offset:256 nt
  s_add_u32 s40, s40, 3072
  s_waitcnt vmcnt(9)
  buffer_load_dwordx4 v[224:227], v1, s[28:31], s40 offen offset:0 nt
  buffer_load_dwordx4 v[228:231], v1, s[28:31], s40 offen offset:128 nt
  buffer_load_dwordx4 v[232:235], v1, s[28:31], s40 offen offset:256 nt
  s_add_u32 s40, s40, 3072
  s_waitcnt vmcnt(9)
  buffer_load_dwordx4 v[236:239], v1, s[28:31], s40 offen offset:0 nt
  buffer_load_dwordx4 v[240:243], v1, s[28:31], s40 offen offset:128 nt
  buffer_load_dwordx4 v[244:247], v1, s[28:31], s40 offen offset:256 nt
  s_add_u32 s40, s40, 3072
  s_waitcnt vmcnt(9)
  buffer_load_dwordx4 v[56:59], v1, s[28:31], s40 offen offset:0 nt
  buffer_load_dwordx4 v[60:63], v1, s[28:31], s40 offen offset:128 nt
  buffer_load_dwordx4 v[64:67], v1, s[28:31], s40 offen offset:256 nt
  s_add_u32 s40, s40, 3072
  s_waitcnt vmcnt(9)
  buffer_load_dwordx4 v[68:71], v1, s[28:31], s40 offen offset:0 nt
  buffer_load_dwordx4 v[72:75], v1, s[28:31], s40 offen offset:128 nt
  buffer_load_dwordx4 v[76:79], v1, s[28:31], s40 offen offset:256 nt
  s_add_u32 s40, s40, 3072
  v_mov_b32 v10, 4096
  s_mov_b32 s46, 262144
L_pollq_55:
  ds_read_b32 v4, v10 offset:4
  s_waitcnt lgkmcnt(0)
  v_readfirstlane_b32 s44, v4
  s_cmp_ge_u32 s44, 1
  s_cbranch_scc1 L_pollq_done_56
  s_sub_u32 s46, s46, 1
  s_cbranch_scc1 L_pollq_done_56
  s_sleep 1
  s_branch L_pollq_55
L_pollq_done_56:
  v_and_b32 v4, 7, v0
  v_lshlrev_b32 v4, 4, v4
  ds_read_b128 v[44:47], v4 offset:3328
  ds_read_b128 v[48:51], v4 offset:3456
  ds_read_b128 v[52:55], v4 offset:3584
  s_waitcnt lgkmcnt(0)
  s_waitcnt vmcnt(45)
  v_mov_b32 v4, 0
  v_mov_b32 v5, 0
  v_dot2c_f32_bf16 v4, v80, v44
  v_dot2c_f32_bf16 v5, v81, v45
  v_dot2c_f32_bf16 v4, v82, v46
  v_dot2c_f32_bf16 v5, v83, v47
  v_dot2c_f32_bf16 v4, v84, v48
  v_dot2c_f32_bf16 v5, v85, v49
  v_dot2c_f32_bf16 v4, v86, v50
  v_dot2c_f32_bf16 v5, v87, v51
  v_dot2c_f32_bf16 v4, v88, v52
  v_dot2c_f32_bf16 v5, v89, v53
  v_dot2c_f32_bf16 v4, v90, v54
  v_dot2c_f32_bf16 v5, v91, v55
  buffer_load_dwordx4 v[80:83], v1, s[28:31], s40 offen offset:0 nt
  buffer_load_dwordx4 v[84:87], v1, s[28:31], s40 offen offset:128 nt
  buffer_load_dwordx4 v[88:91], v1, s[28:31], s40 offen offset:256 nt
  s_add_u32 s40, s40, 3072
  v_add_f32 v4, v4, v5
  s_nop 1
  v_add_f32_dpp v4, v4, v4 quad_perm:[1,0,3,2] row_mask:0xf bank_mask:0xf
  s_nop 1
  v_add_f32_dpp v4, v4, v4 quad_perm:[2,3,0,1] row_mask:0xf bank_mask:0xf
  s_nop 1
  v_add_f32_dpp v4, v4, v4 row_half_mirror row_mask:0xf bank_mask:0xf
  v_cvt_pk_bf16_f32 v4, 0, v4
  v_mul_f32 v4, s54, v4
  v_cvt_pk_bf16_f32 v4, 0, v4
  ds_write_b32 v11, v4
  v_add_u32 v11, 256, v11
  v_max_f32 v2, v2, v4
  s_waitcnt vmcnt(45)
  v_mov_b32 v4, 0
  v_mov_b32 v5, 0
  v_dot2c_f32_bf16 v4, v92, v44
  v_dot2c_f32_bf16 v5, v93, v45
  v_dot2c_f32_bf16 v4, v94, v46
  v_dot2c_f32_bf16 v5, v95, v47
  v_dot2c_f32_bf16 v4, v96, v48
  v_dot2c_f32_bf16 v5, v97, v49
  v_dot2c_f32_bf16 v4, v98, v50
  v_dot2c_f32_bf16 v5, v99, v51
  v_dot2c_f32_bf16 v4, v100, v52
  v_dot2c_f32_bf16 v5, v101, v53
  v_dot2c_f32_bf16 v4, v102, v54
  v_dot2c_f32_bf16 v5, v103, v55
  buffer_load_dwordx4 v[92:95], v1, s[28:31], s40 offen offset:0 nt
  buffer_load_dwordx4 v[96:99], v1, s[28:31], s40 offen offset:128 nt
  buffer_load_dwordx4 v[100:103], v1, s[28:31], s40 offen offset:256 nt
  s_add_u32 s40, s40, 3072
  v_add_f32 v4, v4, v5
  s_nop 1
  v_add_f32_dpp v4, v4, v4 quad_perm:[1,0,3,2] row_mask:0xf bank_mask:0xf
  s_nop 1
  v_add_f32_dpp v4, v4, v4 quad_perm:[2,3,0,1] row_mask:0xf bank_mask:0xf
  s_nop 1
  v_add_f32_dpp v4, v4, v4 row_half_mirror row_mask:0xf bank_mask:0xf
  v_cvt_pk_bf16_f32 v4, 0, v4
  v_mul_f32 v4, s54, v4
  v_cvt_pk_bf16_f32 v4, 0, v4
  ds_write_b32 v11, v4
  v_add_u32 v11, 256, v11
  v_max_f32 v2, v2, v4
  s_waitcnt vmcnt(45)
  v_mov_b32 v4, 0
  v_mov_b32 v5, 0
  v_dot2c_f32_bf16 v4, v104, v44
  v_dot2c_f32_bf16 v5, v105, v45
  v_dot2c_f32_bf16 v4, v106, v46
  v_dot2c_f32_bf16 v5, v107, v47
  v_dot2c_f32_bf16 v4, v108, v48
  v_dot2c_f32_bf16 v5, v109, v49
  v_dot2c_f32_bf16 v4, v110, v50
  v_dot2c_f32_bf16 v5, v111, v51
  v_dot2c_f32_bf16 v4, v112, v52
  v_dot2c_f32_bf16 v5, v113, v53
  v_dot2c_f32_bf16 v4, v114, v54
  v_dot2c_f32_bf16 v5, v115, v55
  s_nop 2
  v_add_f32 v4, v4, v5
  s_nop 1
  v_add_f32_dpp v4, v4, v4 quad_perm:[1,0,3,2] row_mask:0xf bank_mask:0xf
  s_nop 1
  v_add_f32_dpp v4, v4, v4 quad_perm:[2,3,0,1] row_mask:0xf bank_mask:0xf
  s_nop 1
  v_add_f32_dpp v4, v4, v4 row_half_mirror row_mask:0xf bank_mask:0xf
  v_cvt_pk_bf16_f32 v4, 0, v4
  v_mul_f32 v4, s54, v4
  v_cvt_pk_bf16_f32 v4, 0, v4
  ds_write_b32 v11, v4
  v_add_u32 v11, 256, v11
  v_max_f32 v2, v2, v4
  s_waitcnt vmcnt(42)
  v_mov_b32 v4, 0
  v_mov_b32 v5, 0
  v_dot2c_f32_bf16 v4, v116, v44
  v_dot2c_f32_bf16 v5, v117, v45
  v_dot2c_f32_bf16 v4, v118, v46
  v_dot2c_f32_bf16 v5, v119, v47
  v_dot2c_f32_bf16 v4, v120, v48
  v_dot2c_f32_bf16 v5, v121, v49
  v_dot2c_f32_bf16 v4, v122, v50
  v_dot2c_f32_bf16 v5, v123, v51
  v_dot2c_f32_bf16 v4, v124, v52
  v_dot2c_f32_bf16 v5, v125, v53
  v_dot2c_f32_bf16 v4, v126, v54
  v_dot2c_f32_bf16 v5, v127, v55
  s_nop 2
  v_add_f32 v4, v4, v5
  s_nop 1
  v_add_f32_dpp v4, v4, v4 quad_perm:[1,0,3,2] row_mask:0xf bank_mask:0xf
  s_nop 1
  v_add_f32_dpp v4, v4, v4 quad_perm:[2,3,0,1] row_mask:0xf bank_mask:0xf
  s_nop 1
  v_add_f32_dpp v4, v4, v4 row_half_mirror row_mask:0xf bank_mask:0xf
  v_cvt_pk_bf16_f32 v4, 0, v4
  v_mul_f32 v4, s54, v4
  v_cvt_pk_bf16_f32 v4, 0, v4
  ds_write_b32 v11, v4
  v_add_u32 v11, 256, v11
  v_max_f32 v2, v2, v4
  s_waitcnt vmcnt(39)
  v_mov_b32 v4, 0
  v_mov_b32 v5, 0
  v_dot2c_f32_bf16 v4, v128, v44
  v_dot2c_f32_bf16 v5, v129, v45
  v_dot2c_f32_bf16 v4, v130, v46
  v_dot2c_f32_bf16 v5, v131, v47
  v_dot2c_f32_bf16 v4, v132, v48
  v_dot2c_f32_bf16 v5, v133, v49
  v_dot2c_f32_bf16 v4, v134, v50
  v_dot2c_f32_bf16 v5, v135, v51
  v_dot2c_f32_bf16 v4, v136, v52
  v_dot2c_f32_bf16 v5, v137, v53
  v_dot2c_f32_bf16 v4, v138, v54
  v_dot2c_f32_bf16 v5, v139, v55
  s_nop 2
  v_add_f32 v4, v4, v5
  s_nop 1
  v_add_f32_dpp v4, v4, v4 quad_perm:[1,0,3,2] row_mask:0xf bank_mask:0xf
  s_nop 1
  v_add_f32_dpp v4, v4, v4 quad_perm:[2,3,0,1] row_mask:0xf bank_mask:0xf
  s_nop 1
  v_add_f32_dpp v4, v4, v4 row_half_mirror row_mask:0xf bank_mask:0xf
  v_cvt_pk_bf16_f32 v4, 0, v4
  v_mul_f32 v4, s54, v4
  v_cvt_pk_bf16_f32 v4, 0, v4
  ds_write_b32 v11, v4
  v_add_u32 v11, 256, v11
  v_max_f32 v2, v2, v4
  s_waitcnt vmcnt(36)
  v_mov_b32 v4, 0
  v_mov_b32 v5, 0
  v_dot2c_f32_bf16 v4, v140, v44
  v_dot2c_f32_bf16 v5, v141, v45
  v_dot2c_f32_bf16 v4, v142, v46
  v_dot2c_f32_bf16 v5, v143, v47
  v_dot2c_f32_bf16 v4, v144, v48
  v_dot2c_f32_bf16 v5, v145, v49
  v_dot2c_f32_bf16 v4, v146, v50
  v_dot2c_f32_bf16 v5, v147, v51
  v_dot2c_f32_bf16 v4, v148, v52
  v_dot2c_f32_bf16 v5, v149, v53
  v_dot2c_f32_bf16 v4, v150, v54
  v_dot2c_f32_bf16 v5, v151, v55
  s_nop 2
  v_add_f32 v4, v4, v5
  s_nop 1
  v_add_f32_dpp v4, v4, v4 quad_perm:[1,0,3,2] row_mask:0xf bank_mask:0xf
  s_nop 1
  v_add_f32_dpp v4, v4, v4 quad_perm:[2,3,0,1] row_mask:0xf bank_mask:0xf
  s_nop 1
  v_add_f32_dpp v4, v4, v4 row_half_mirror row_mask:0xf bank_mask:0xf
  v_cvt_pk_bf16_f32 v4, 0, v4
  v_mul_f32 v4, s54, v4
  v_cvt_pk_bf16_f32 v4, 0, v4
  ds_write_b32 v11, v4
  v_add_u32 v11, 256, v11
  v_max_f32 v2, v2, v4
  s_waitcnt vmcnt(33)
  v_mov_b32 v4, 0
  v_mov_b32 v5, 0
  v_dot2c_f32_bf16 v4, v152, v44
  v_dot2c_f32_bf16 v5, v153, v45
  v_dot2c_f32_bf16 v4, v154, v46
  v_dot2c_f32_bf16 v5, v155, v47
  v_dot2c_f32_bf16 v4, v156, v48
  v_dot2c_f32_bf16 v5, v157, v49
  v_dot2c_f32_bf16 v4, v158, v50
  v_dot2c_f32_bf16 v5, v159, v51
  v_dot2c_f32_bf16 v4, v160, v52
  v_dot2c_f32_bf16 v5, v161, v53
  v_dot2c_f32_bf16 v4, v162, v54
  v_dot2c_f32_bf16 v5, v163, v55
  s_nop 2
  v_add_f32 v4, v4, v5
  s_nop 1
  v_add_f32_dpp v4, v4, v4 quad_perm:[1,0,3,2] row_mask:0xf bank_mask:0xf
  s_nop 1
  v_add_f32_dpp v4, v4, v4 quad_perm:[2,3,0,1] row_mask:0xf bank_mask:0xf
  s_nop 1
  v_add_f32_dpp v4, v4, v4 row_half_mirror row_mask:0xf bank_mask:0xf
  v_cvt_pk_bf16_f32 v4, 0, v4
  v_mul_f32 v4, s54, v4
  v_cvt_pk_bf16_f32 v4, 0, v4
  ds_write_b32 v11, v4
  v_add_u32 v11, 256, v11
  v_max_f32 v2, v2, v4
  s_waitcnt vmcnt(30)
  v_mov_b32 v4, 0
  v_mov_b32 v5, 0
  v_dot2c_f32_bf16 v4, v164, v44
  v_dot2c_f32_bf16 v5, v165, v45
  v_dot2c_f32_bf16 v4, v166, v46
  v_dot2c_f32_bf16 v5, v167, v47
  v_dot2c_f32_bf16 v4, v168, v48
  v_dot2c_f32_bf16 v5, v169, v49
  v_dot2c_f32_bf16 v4, v170, v50
  v_dot2c_f32_bf16 v5, v171, v51
  v_dot2c_f32_bf16 v4, v172, v52
  v_dot2c_f32_bf16 v5, v173, v53
  v_dot2c_f32_bf16 v4, v174, v54
  v_dot2c_f32_bf16 v5, v175, v55
  s_nop 2
  v_add_f32 v4, v4, v5
  s_nop 1
  v_add_f32_dpp v4, v4, v4 quad_perm:[1,0,3,2] row_mask:0xf bank_mask:0xf
  s_nop 1
  v_add_f32_dpp v4, v4, v4 quad_perm:[2,3,0,1] row_mask:0xf bank_mask:0xf
  s_nop 1
  v_add_f32_dpp v4, v4, v4 row_half_mirror row_mask:0xf bank_mask:0xf
  v_cvt_pk_bf16_f32 v4, 0, v4
  v_mul_f32 v4, s54, v4
  v_cvt_pk_bf16_f32 v4, 0, v4
  ds_write_b32 v11, v4
  v_add_u32 v11, 256, v11
  v_max_f32 v2, v2, v4
  s_waitcnt vmcnt(27)
  v_mov_b32 v4, 0
  v_mov_b32 v5, 0
  v_dot2c_f32_bf16 v4, v176, v44
  v_dot2c_f32_bf16 v5, v177, v45
  v_dot2c_f32_bf16 v4, v178, v46
  v_dot2c_f32_bf16 v5, v179, v47
  v_dot2c_f32_bf16 v4, v180, v48
  v_dot2c_f32_bf16 v5, v181, v49
  v_dot2c_f32_bf16 v4, v182, v50
  v_dot2c_f32_bf16 v5, v183, v51
  v_dot2c_f32_bf16 v4, v184, v52
  v_dot2c_f32_bf16 v5, v185, v53
  v_dot2c_f32_bf16 v4, v186, v54
  v_dot2c_f32_bf16 v5, v187, v55
  s_nop 2
  v_add_f32 v4, v4, v5
  s_nop 1
  v_add_f32_dpp v4, v4, v4 quad_perm:[1,0,3,2] row_mask:0xf bank_mask:0xf
  s_nop 1
  v_add_f32_dpp v4, v4, v4 quad_perm:[2,3,0,1] row_mask:0xf bank_mask:0xf
  s_nop 1
  v_add_f32_dpp v4, v4, v4 row_half_mirror row_mask:0xf bank_mask:0xf
  v_cvt_pk_bf16_f32 v4, 0, v4
  v_mul_f32 v4, s54, v4
  v_cvt_pk_bf16_f32 v4, 0, v4
  ds_write_b32 v11, v4
  v_add_u32 v11, 256, v11
  v_max_f32 v2, v2, v4
  s_waitcnt vmcnt(24)
  v_mov_b32 v4, 0
  v_mov_b32 v5, 0
  v_dot2c_f32_bf16 v4, v188, v44
  v_dot2c_f32_bf16 v5, v189, v45
  v_dot2c_f32_bf16 v4, v190, v46
  v_dot2c_f32_bf16 v5, v191, v47
  v_dot2c_f32_bf16 v4, v192, v48
  v_dot2c_f32_bf16 v5, v193, v49
  v_dot2c_f32_bf16 v4, v194, v50
  v_dot2c_f32_bf16 v5, v195, v51
  v_dot2c_f32_bf16 v4, v196, v52
  v_dot2c_f32_bf16 v5, v197, v53
  v_dot2c_f32_bf16 v4, v198, v54
  v_dot2c_f32_bf16 v5, v199, v55
  s_nop 2
  v_add_f32 v4, v4, v5
  s_nop 1
  v_add_f32_dpp v4, v4, v4 quad_perm:[1,0,3,2] row_mask:0xf bank_mask:0xf
  s_nop 1
  v_add_f32_dpp v4, v4, v4 quad_perm:[2,3,0,1] row_mask:0xf bank_mask:0xf
  s_nop 1
  v_add_f32_dpp v4, v4, v4 row_half_mirror row_mask:0xf bank_mask:0xf
  v_cvt_pk_bf16_f32 v4, 0, v4
  v_mul_f32 v4, s54, v4
  v_cvt_pk_bf16_f32 v4, 0, v4
  ds_write_b32 v11, v4
  v_add_u32 v11, 256, v11
  v_max_f32 v2, v2, v4
  s_waitcnt vmcnt(21)
  v_mov_b32 v4, 0
  v_mov_b32 v5, 0
  v_dot2c_f32_bf16 v4, v200, v44
  v_dot2c_f32_bf16 v5, v201, v45
  v_dot2c_f32_bf16 v4, v202, v46
  v_dot2c_f32_bf16 v5, v203, v47
  v_dot2c_f32_bf16 v4, v204, v48
  v_dot2c_f32_bf16 v5, v205, v49
  v_dot2c_f32_bf16 v4, v206, v50
  v_dot2c_f32_bf16 v5, v207, v51
  v_dot2c_f32_bf16 v4, v208, v52
  v_dot2c_f32_bf16 v5, v209, v53
  v_dot2c_f32_bf16 v4, v210, v54
  v_dot2c_f32_bf16 v5, v211, v55
  s_nop 2
  v_add_f32 v4, v4, v5
  s_nop 1
  v_add_f32_dpp v4, v4, v4 quad_perm:[1,0,3,2] row_mask:0xf bank_mask:0xf
  s_nop 1
  v_add_f32_dpp v4, v4, v4 quad_perm:[2,3,0,1] row_mask:0xf bank_mask:0xf
  s_nop 1
  v_add_f32_dpp v4, v4, v4 row_half_mirror row_mask:0xf bank_mask:0xf
  v_cvt_pk_bf16_f32 v4, 0, v4
  v_mul_f32 v4, s54, v4
  v_cvt_pk_bf16_f32 v4, 0, v4
  ds_write_b32 v11, v4
  v_add_u32 v11, 256, v11
  v_max_f32 v2, v2, v4
  s_waitcnt vmcnt(18)
  v_mov_b32 v4, 0
  v_mov_b32 v5, 0
  v_dot2c_f32_bf16 v4, v212, v44
  v_dot2c_f32_bf16 v5, v213, v45
  v_dot2c_f32_bf16 v4, v214, v46
  v_dot2c_f32_bf16 v5, v215, v47
  v_dot2c_f32_bf16 v4, v216, v48
  v_dot2c_f32_bf16 v5, v217, v49
  v_dot2c_f32_bf16 v4, v218, v50
  v_dot2c_f32_bf16 v5, v219, v51
  v_dot2c_f32_bf16 v4, v220, v52
  v_dot2c_f32_bf16 v5, v221, v53
  v_dot2c_f32_bf16 v4, v222, v54
  v_dot2c_f32_bf16 v5, v223, v55
  s_nop 2
  v_add_f32 v4, v4, v5
  s_nop 1
  v_add_f32_dpp v4, v4, v4 quad_perm:[1,0,3,2] row_mask:0xf bank_mask:0xf
  s_nop 1
  v_add_f32_dpp v4, v4, v4 quad_perm:[2,3,0,1] row_mask:0xf bank_mask:0xf
  s_nop 1
  v_add_f32_dpp v4, v4, v4 row_half_mirror row_mask:0xf bank_mask:0xf
  v_cvt_pk_bf16_f32 v4, 0, v4
  v_mul_f32 v4, s54, v4
  v_cvt_pk_bf16_f32 v4, 0, v4
  ds_write_b32 v11, v4
  v_add_u32 v11, 256, v11
  v_max_f32 v2, v2, v4
  s_waitcnt vmcnt(15)
  v_mov_b32 v4, 0
  v_mov_b32 v5, 0
  v_dot2c_f32_bf16 v4, v224, v44
  v_dot2c_f32_bf16 v5, v225, v45
  v_dot2c_f32_bf16 v4, v226, v46
  v_dot2c_f32_bf16 v5, v227, v47
  v_dot2c_f32_bf16 v4, v228, v48
  v_dot2c_f32_bf16 v5, v229, v49
  v_dot2c_f32_bf16 v4, v230, v50
  v_dot2c_f32_bf16 v5, v231, v51
  v_dot2c_f32_bf16 v4, v232, v52
  v_dot2c_f32_bf16 v5, v233, v53
  v_dot2c_f32_bf16 v4, v234, v54
  v_dot2c_f32_bf16 v5, v235, v55
  s_nop 2
  v_add_f32 v4, v4, v5
  s_nop 1
  v_add_f32_dpp v4, v4, v4 quad_perm:[1,0,3,2] row_mask:0xf bank_mask:0xf
  s_nop 1
  v_add_f32_dpp v4, v4, v4 quad_perm:[2,3,0,1] row_mask:0xf bank_mask:0xf
  s_nop 1
  v_add_f32_dpp v4, v4, v4 row_half_mirror row_mask:0xf bank_mask:0xf
  v_cvt_pk_bf16_f32 v4, 0, v4
  v_mul_f32 v4, s54, v4
  v_cvt_pk_bf16_f32 v4, 0, v4
  ds_write_b32 v11, v4
  v_add_u32 v11, 256, v11
  v_max_f32 v2, v2, v4
  s_waitcnt vmcnt(12)
  v_mov_b32 v4, 0
  v_mov_b32 v5, 0
  v_dot2c_f32_bf16 v4, v236, v44
  v_dot2c_f32_bf16 v5, v237, v45
  v_dot2c_f32_bf16 v4, v238, v46
  v_dot2c_f32_bf16 v5, v239, v47
  v_dot2c_f32_bf16 v4, v240, v48
  v_dot2c_f32_bf16 v5, v241, v49
  v_dot2c_f32_bf16 v4, v242, v50
  v_dot2c_f32_bf16 v5, v243, v51
  v_dot2c_f32_bf16 v4, v244, v52
  v_dot2c_f32_bf16 v5, v245, v53
  v_dot2c_f32_bf16 v4, v246, v54
  v_dot2c_f32_bf16 v5, v247, v55
  s_nop 2
  v_add_f32 v4, v4, v5
  s_nop 1
  v_add_f32_dpp v4, v4, v4 quad_perm:[1,0,3,2] row_mask:0xf bank_mask:0xf
  s_nop 1
  v_add_f32_dpp v4, v4, v4 quad_perm:[2,3,0,1] row_mask:0xf bank_mask:0xf
  s_nop 1
  v_add_f32_dpp v4, v4, v4 row_half_mirror row_mask:0xf bank_mask:0xf
  v_cvt_pk_bf16_f32 v4, 0, v4
  v_mul_f32 v4, s54, v4
  v_cvt_pk_bf16_f32 v4, 0, v4
  ds_write_b32 v11, v4
  v_add_u32 v11, 256, v11
  v_max_f32 v2, v2, v4
  s_waitcnt vmcnt(9)
  v_mov_b32 v4, 0
  v_mov_b32 v5, 0
  v_dot2c_f32_bf16 v4, v56, v44
  v_dot2c_f32_bf16 v5, v57, v45
  v_dot2c_f32_bf16 v4, v58, v46
  v_dot2c_f32_bf16 v5, v59, v47
  v_dot2c_f32_bf16 v4, v60, v48
  v_dot2c_f32_bf16 v5, v61, v49
  v_dot2c_f32_bf16 v4, v62, v50
  v_dot2c_f32_bf16 v5, v63, v51
  v_dot2c_f32_bf16 v4, v64, v52
  v_dot2c_f32_bf16 v5, v65, v53
  v_dot2c_f32_bf16 v4, v66, v54
  v_dot2c_f32_bf16 v5, v67, v55
  s_nop 2
  v_add_f32 v4, v4, v5
  s_nop 1
  v_add_f32_dpp v4, v4, v4 quad_perm:[1,0,3,2] row_mask:0xf bank_mask:0xf
  s_nop 1
  v_add_f32_dpp v4, v4, v4 quad_perm:[2,3,0,1] row_mask:0xf bank_mask:0xf
  s_nop 1
  v_add_f32_dpp v4, v4, v4 row_half_mirror row_mask:0xf bank_mask:0xf
  v_cvt_pk_bf16_f32 v4, 0, v4
  v_mul_f32 v4, s54, v4
  v_cvt_pk_bf16_f32 v4, 0, v4
  ds_write_b32 v11, v4
  v_add_u32 v11, 256, v11
  v_max_f32 v2, v2, v4
  s_waitcnt vmcnt(6)
  v_mov_b32 v4, 0
  v_mov_b32 v5, 0
  v_dot2c_f32_bf16 v4, v68, v44
  v_dot2c_f32_bf16 v5, v69, v45
  v_dot2c_f32_bf16 v4, v70, v46
  v_dot2c_f32_bf16 v5, v71, v47
  v_dot2c_f32_bf16 v4, v72, v48
  v_dot2c_f32_bf16 v5, v73, v49
  v_dot2c_f32_bf16 v4, v74, v50
  v_dot2c_f32_bf16 v5, v75, v51
  v_dot2c_f32_bf16 v4, v76, v52
  v_dot2c_f32_bf16 v5, v77, v53
  v_dot2c_f32_bf16 v4, v78, v54
  v_dot2c_f32_bf16 v5, v79, v55
  s_nop 2
  v_add_f32 v4, v4, v5
  s_nop 1
  v_add_f32_dpp v4, v4, v4 quad_perm:[1,0,3,2] row_mask:0xf bank_mask:0xf
  s_nop 1
  v_add_f32_dpp v4, v4, v4 quad_perm:[2,3,0,1] row_mask:0xf bank_mask:0xf
  s_nop 1
  v_add_f32_dpp v4, v4, v4 row_half_mirror row_mask:0xf bank_mask:0xf
  v_cvt_pk_bf16_f32 v4, 0, v4
  v_mul_f32 v4, s54, v4
  v_cvt_pk_bf16_f32 v4, 0, v4
  ds_write_b32 v11, v4
  v_add_u32 v11, 256, v11
  v_max_f32 v2, v2, v4
  v_mov_b32 v56, 0
  v_mov_b32 v57, 0
  v_mov_b32 v58, 0
  v_mov_b32 v59, 0
  v_mov_b32 v60, 0
  v_mov_b32 v61, 0
  v_mov_b32 v62, 0
  v_mov_b32 v63, 0
  v_mov_b32 v64, 0
  v_mov_b32 v65, 0
  v_mov_b32 v66, 0
  v_mov_b32 v67, 0
  v_mov_b32 v68, 0
  v_mov_b32 v69, 0
  v_mov_b32 v70, 0
  v_mov_b32 v71, 0
  v_mov_b32 v72, 0
  v_mov_b32 v73, 0
  v_mov_b32 v74, 0
  v_mov_b32 v75, 0
  v_mov_b32 v76, 0
  v_mov_b32 v77, 0
  v_mov_b32 v78, 0
  v_mov_b32 v79, 0
  s_add_u32 s43, s66, 43
L_seg_57:
  s_waitcnt vmcnt(3)
  v_mov_b32 v4, 0
  v_mov_b32 v5, 0
  v_dot2c_f32_bf16 v4, v80, v44
  v_dot2c_f32_bf16 v5, v81, v45
  v_dot2c_f32_bf16 v4, v82, v46
  v_dot2c_f32_bf16 v5, v83, v47
  v_dot2c_f32_bf16 v4, v84, v48
  v_dot2c_f32_bf16 v5, v85, v49
  v_dot2c_f32_bf16 v4, v86, v50
  v_dot2c_f32_bf16 v5, v87, v51
  v_dot2c_f32_bf16 v4, v88, v52
  v_dot2c_f32_bf16 v5, v89, v53
  v_dot2c_f32_bf16 v4, v90, v54
  v_dot2c_f32_bf16 v5, v91, v55
  buffer_load_dwordx4 v[80:83], v1, s[28:31], s40 offen offset:0 nt
  buffer_load_dwordx4 v[84:87], v1, s[28:31], s40 offen offset:128 nt
  buffer_load_dwordx4 v[88:91], v1, s[28:31], s40 offen offset:256 nt
  s_add_u32 s40, s40, 3072
  v_add_f32 v4, v4, v5
  s_nop 1
  v_add_f32_dpp v4, v4, v4 quad_perm:[1,0,3,2] row_mask:0xf bank_mask:0xf
  s_nop 1
  v_add_f32_dpp v4, v4, v4 quad_perm:[2,3,0,1] row_mask:0xf bank_mask:0xf
  s_nop 1
  v_add_f32_dpp v4, v4, v4 row_half_mirror row_mask:0xf bank_mask:0xf
  v_cvt_pk_bf16_f32 v4, 0, v4
  v_mul_f32 v4, s54, v4
  v_cvt_pk_bf16_f32 v4, 0, v4
  ds_write_b32 v11, v4
  v_add_u32 v11, 256, v11
  v_max_f32 v2, v2, v4
  s_waitcnt vmcnt(3)
  v_mov_b32 v4, 0
  v_mov_b32 v5, 0
  v_dot2c_f32_bf16 v4, v92, v44
  v_dot2c_f32_bf16 v5, v93, v45
  v_dot2c_f32_bf16 v4, v94, v46
  v_dot2c_f32_bf16 v5, v95, v47
  v_dot2c_f32_bf16 v4, v96, v48
  v_dot2c_f32_bf16 v5, v97, v49
  v_dot2c_f32_bf16 v4, v98, v50
  v_dot2c_f32_bf16 v5, v99, v51
  v_dot2c_f32_bf16 v4, v100, v52
  v_dot2c_f32_bf16 v5, v101, v53
  v_dot2c_f32_bf16 v4, v102, v54
  v_dot2c_f32_bf16 v5, v103, v55
  buffer_load_dwordx4 v[92:95], v1, s[28:31], s40 offen offset:0 nt
  buffer_load_dwordx4 v[96:99], v1, s[28:31], s40 offen offset:128 nt
  buffer_load_dwordx4 v[100:103], v1, s[28:31], s40 offen offset:256 nt
  s_add_u32 s40, s40, 3072
  v_add_f32 v4, v4, v5
  s_nop 1
  v_add_f32_dpp v4, v4, v4 quad_perm:[1,0,3,2] row_mask:0xf bank_mask:0xf
  s_nop 1
  v_add_f32_dpp v4, v4, v4 quad_perm:[2,3,0,1] row_mask:0xf bank_mask:0xf
  s_nop 1
  v_add_f32_dpp v4, v4, v4 row_half_mirror row_mask:0xf bank_mask:0xf
  v_cvt_pk_bf16_f32 v4, 0, v4
  v_mul_f32 v4, s54, v4
  v_cvt_pk_bf16_f32 v4, 0, v4
  ds_write_b32 v11, v4
  v_add_u32 v11, 256, v11
  v_max_f32 v2, v2, v4
  s_sub_u32 s43, s43, 1
  s_cmp_lg_u32 s43, 0
  s_cbranch_scc1 L_seg_57
  s_mov_b32 s40, s42
  s_waitcnt vmcnt(3)
  v_mov_b32 v4, 0
  v_mov_b32 v5, 0
  v_dot2c_f32_bf16 v4, v80, v44
  v_dot2c_f32_bf16 v5, v81, v45
  v_dot2c_f32_bf16 v4, v82, v46
  v_dot2c_f32_bf16 v5, v83, v47
  v_dot2c_f32_bf16 v4, v84, v48
  v_dot2c_f32_bf16 v5, v85, v49
  v_dot2c_f32_bf16 v4, v86, v50
  v_dot2c_f32_bf16 v5, v87, v51
  v_dot2c_f32_bf16 v4, v88, v52
  v_dot2c_f32_bf16 v5, v89, v53
  v_dot2c_f32_bf16 v4, v90, v54
  v_dot2c_f32_bf16 v5, v91, v55
  buffer_load_dwordx4 v[80:83], v1, s[32:35], s40 offen offset:0 nt
  buffer_load_dwordx4 v[84:87], v1, s[32:35], s40 offen offset:128 nt
  buffer_load_dwordx4 v[88:91], v1, s[32:35], s40 offen offset:256 nt
  s_add_u32 s40, s40, 3072
  v_add_f32 v4, v4, v5
  s_nop 1
  v_add_f32_dpp v4, v4, v4 quad_perm:[1,0,3,2] row_mask:0xf bank_mask:0xf
  s_nop 1
  v_add_f32_dpp v4, v4, v4 quad_perm:[2,3,0,1] row_mask:0xf bank_mask:0xf
  s_nop 1
  v_add_f32_dpp v4, v4, v4 row_half_mirror row_mask:0xf bank_mask:0xf
  v_cvt_pk_bf16_f32 v4, 0, v4
  v_mul_f32 v4, s54, v4
  v_cvt_pk_bf16_f32 v4, 0, v4
  ds_write_b32 v11, v4
  v_add_u32 v11, 256, v11
  v_max_f32 v2, v2, v4
  s_waitcnt vmcnt(3)
  v_mov_b32 v4, 0
  v_mov_b32 v5, 0
  v_dot2c_f32_bf16 v4, v92, v44
  v_dot2c_f32_bf16 v5, v93, v45
  v_dot2c_f32_bf16 v4, v94, v46
  v_dot2c_f32_bf16 v5, v95, v47
  v_dot2c_f32_bf16 v4, v96, v48
  v_dot2c_f32_bf16 v5, v97, v49
  v_dot2c_f32_bf16 v4, v98, v50
  v_dot2c_f32_bf16 v5, v99, v51
  v_dot2c_f32_bf16 v4, v100, v52
  v_dot2c_f32_bf16 v5, v101, v53
  v_dot2c_f32_bf16 v4, v102, v54
  v_dot2c_f32_bf16 v5, v103, v55
  buffer_load_dwordx4 v[92:95], v1, s[32:35], s40 offen offset:0 nt
  buffer_load_dwordx4 v[96:99], v1, s[32:35], s40 offen offset:128 nt
  buffer_load_dwordx4 v[100:103], v1, s[32:35], s40 offen offset:256 nt
  s_add_u32 s40, s40, 3072
  v_add_f32 v4, v4, v5
  s_nop 1
  v_add_f32_dpp v4, v4, v4 quad_perm:[1,0,3,2] row_mask:0xf bank_mask:0xf
  s_nop 1
  v_add_f32_dpp v4, v4, v4 quad_perm:[2,3,0,1] row_mask:0xf bank_mask:0xf
  s_nop 1
  v_add_f32_dpp v4, v4, v4 row_half_mirror row_mask:0xf bank_mask:0xf
  v_cvt_pk_bf16_f32 v4, 0, v4
  v_mul_f32 v4, s54, v4
  v_cvt_pk_bf16_f32 v4, 0, v4
  ds_write_b32 v11, v4
  v_add_u32 v11, 256, v11
  v_max_f32 v2, v2, v4
  s_nop 1
  v_max_f32_dpp v2, v2, v2 row_ror:8 row_mask:0xf bank_mask:0xf
  v_mov_b32 v6, v2
  s_nop 1
  v_permlane16_swap_b32 v2, v6
  v_max_f32 v2, v2, v6
  v_mov_b32 v6, v2
  s_nop 1
  v_permlane32_swap_b32 v2, v6
  v_max_f32 v2, v2, v6
  s_add_u32 s43, s66, 51
L_seg_58:
  s_cmp_lg_u32 s43, 4
  s_cbranch_scc1 L_nowake_59
  s_mov_b64 exec, 1
  ds_add_u32 v15, v16 offset:20
  s_mov_b64 exec, -1
L_nowake_59:
  ds_read_b32 v4, v12
  v_add_u32 v12, 256, v12
  s_waitcnt lgkmcnt(0)
  v_sub_f32 v6, v4, v2
  v_mul_f32 v6, s55, v6
  v_exp_f32 v6, v6
  s_nop 0
  v_add_f32 v3, v3, v6
  v_cvt_pk_bf16_f32 v7, v6, 0
  v_cvt_pk_bf16_f32 v8, 0, v6
  s_waitcnt vmcnt(3)
  v_dot2c_f32_bf16 v56, v80, v7
  v_dot2c_f32_bf16 v57, v80, v8
  v_dot2c_f32_bf16 v58, v81, v7
  v_dot2c_f32_bf16 v59, v81, v8
  v_dot2c_f32_bf16 v60, v82, v7
  v_dot2c_f32_bf16 v61, v82, v8
  v_dot2c_f32_bf16 v62, v83, v7
  v_dot2c_f32_bf16 v63, v83, v8
  v_dot2c_f32_bf16 v64, v84, v7
  v_dot2c_f32_bf16 v65, v84, v8
  v_dot2c_f32_bf16 v66, v85, v7
  v_dot2c_f32_bf16 v67, v85, v8
  v_dot2c_f32_bf16 v68, v86, v7
  v_dot2c_f32_bf16 v69, v86, v8
  v_dot2c_f32_bf16 v70, v87, v7
  v_dot2c_f32_bf16 v71, v87, v8
  v_dot2c_f32_bf16 v72, v88, v7
  v_dot2c_f32_bf16 v73, v88, v8
  v_dot2c_f32_bf16 v74, v89, v7
  v_dot2c_f32_bf16 v75, v89, v8
  v_dot2c_f32_bf16 v76, v90, v7
  v_dot2c_f32_bf16 v77, v90, v8
  v_dot2c_f32_bf16 v78, v91, v7
  v_dot2c_f32_bf16 v79, v91, v8
  buffer_load_dwordx4 v[80:83], v1, s[32:35], s40 offen offset:0 nt
  buffer_load_dwordx4 v[84:87], v1, s[32:35], s40 offen offset:128 nt
  buffer_load_dwordx4 v[88:91], v1, s[32:35], s40 offen offset:256 nt
  s_add_u32 s40, s40, 3072
  ds_read_b32 v4, v12
  v_add_u32 v12, 256, v12
  s_waitcnt lgkmcnt(0)
  v_sub_f32 v6, v4, v2
  v_mul_f32 v6, s55, v6
  v_exp_f32 v6, v6
  s_nop 0
  v_add_f32 v3, v3, v6
  v_cvt_pk_bf16_f32 v7, v6, 0
  v_cvt_pk_bf16_f32 v8, 0, v6
  s_waitcnt vmcnt(3)
  v_dot2c_f32_bf16 v56, v92, v7
  v_dot2c_f32_bf16 v57, v92, v8
  v_dot2c_f32_bf16 v58, v93, v7
  v_dot2c_f32_bf16 v59, v93, v8
  v_dot2c_f32_bf16 v60, v94, v7
  v_dot2c_f32_bf16 v61, v94, v8
  v_dot2c_f32_bf16 v62, v95, v7
  v_dot2c_f32_bf16 v63, v95, v8
  v_dot2c_f32_bf16 v64, v96, v7
  v_dot2c_f32_bf16 v65, v96, v8
  v_dot2c_f32_bf16 v66, v97, v7
  v_dot2c_f32_bf16 v67, v97, v8
  v_dot2c_f32_bf16 v68, v98, v7
  v_dot2c_f32_bf16 v69, v98, v8
  v_dot2c_f32_bf16 v70, v99, v7
  v_dot2c_f32_bf16 v71, v99, v8
  v_dot2c_f32_bf16 v72, v100, v7
  v_dot2c_f32_bf16 v73, v100, v8
  v_dot2c_f32_bf16 v74, v101, v7
  v_dot2c_f32_bf16 v75, v101, v8
  v_dot2c_f32_bf16 v76, v102, v7
  v_dot2c_f32_bf16 v77, v102, v8
  v_dot2c_f32_bf16 v78, v103, v7
  v_dot2c_f32_bf16 v79, v103, v8
  buffer_load_dwordx4 v[92:95], v1, s[32:35], s40 offen offset:0 nt
  buffer_load_dwordx4 v[96:99], v1, s[32:35], s40 offen offset:128 nt
  buffer_load_dwordx4 v[100:103], v1, s[32:35], s40 offen offset:256 nt
  s_add_u32 s40, s40, 3072
  s_sub_u32 s43, s43, 1
  s_cmp_lg_u32 s43, 0
  s_cbranch_scc1 L_seg_58
  s_mov_b64 exec, 1
  ds_add_rtn_u32 v13, v15, v16 offset:24
  s_mov_b64 exec, -1
  s_waitcnt lgkmcnt(0)
  v_readfirstlane_b32 s44, v13
  s_lshl_b32 s44, s44, 2
  s_add_u32 s44, s44, 8256
  v_mov_b32 v13, s44
  ds_read_b32 v14, v13
  s_waitcnt lgkmcnt(0)
  v_readfirstlane_b32 s47, v14
  ds_read_b32 v4, v12
  v_add_u32 v12, 256, v12
  s_waitcnt lgkmcnt(0)
  v_sub_f32 v6, v4, v2
  v_mul_f32 v6, s55, v6
  v_exp_f32 v6, v6
  s_nop 0
  v_add_f32 v3, v3, v6
  v_cvt_pk_bf16_f32 v7, v6, 0
  v_cvt_pk_bf16_f32 v8, 0, v6
  s_cmp_lg_u32 s47, -1
  s_cbranch_scc1 L_tkw_done_61
  s_mov_b32 s46, 262144
L_tkw_60:
  ds_read_b32 v14, v13
  s_waitcnt lgkmcnt(0)
  v_readfirstlane_b32 s47, v14
  s_cmp_lg_u32 s47, -1
  s_cbranch_scc1 L_tkw_done_61
  s_sub_u32 s46, s46, 1
  s_cbranch_scc1 L_tkw_done_61
  s_sleep 1
  s_branch L_tkw_60
L_tkw_done_61:
  s_mul_i32 s50, s47, 3072
  s_add_u32 s50, s50, s41
  s_cmp_lt_u32 s47, 800
  s_cselect_b32 s50, s50, 2146435072
  s_waitcnt vmcnt(3)
  v_dot2c_f32_bf16 v56, v80, v7
  v_dot2c_f32_bf16 v57, v80, v8
  v_dot2c_f32_bf16 v58, v81, v7
  v_dot2c_f32_bf16 v59, v81, v8
  v_dot2c_f32_bf16 v60, v82, v7
  v_dot2c_f32_bf16 v61, v82, v8
  v_dot2c_f32_bf16 v62, v83, v7
  v_dot2c_f32_bf16 v63, v83, v8
  v_dot2c_f32_bf16 v64, v84, v7
  v_dot2c_f32_bf16 v65, v84, v8
  v_dot2c_f32_bf16 v66, v85, v7
  v_dot2c_f32_bf16 v67, v85, v8
  v_dot2c_f32_bf16 v68, v86, v7
  v_dot2c_f32_bf16 v69, v86, v8
  v_dot2c_f32_bf16 v70, v87, v7
  v_dot2c_f32_bf16 v71, v87, v8
  v_dot2c_f32_bf16 v72, v88, v7
  v_dot2c_f32_bf16 v73, v88, v8
  v_dot2c_f32_bf16 v74, v89, v7
  v_dot2c_f32_bf16 v75, v89, v8
  v_dot2c_f32_bf16 v76, v90, v7
  v_dot2c_f32_bf16 v77, v90, v8
  v_dot2c_f32_bf16 v78, v91, v7
  v_dot2c_f32_bf16 v79, v91, v8
  buffer_load_dwordx4 v[80:83], v1, s[28:31], s50 offen offset:0 nt
  buffer_load_dwordx4 v[84:87], v1, s[28:31], s50 offen offset:128 nt
  buffer_load_dwordx4 v[88:91], v1, s[28:31], s50 offen offset:256 nt
  ds_read_b32 v4, v12
  v_add_u32 v12, 256, v12
  s_mov_b64 exec, 1
  ds_add_rtn_u32 v13, v15, v16 offset:24
  s_mov_b64 exec, -1
  s_waitcnt lgkmcnt(1)
  v_sub_f32 v6, v4, v2
  v_mul_f32 v6, s55, v6
  v_exp_f32 v6, v6
  s_nop 0
  v_add_f32 v3, v3, v6
  v_cvt_pk_bf16_f32 v7, v6, 0
  v_cvt_pk_bf16_f32 v8, 0, v6
  s_waitcnt lgkmcnt(0)
  v_readfirstlane_b32 s44, v13
  s_lshl_b32 s44, s44, 2
  s_add_u32 s44, s44, 8256
  v_mov_b32 v13, s44
  ds_read_b32 v14, v13
  s_waitcnt vmcnt(3)
  v_dot2c_f32_bf16 v56, v92, v7
  v_dot2c_f32_bf16 v57, v92, v8
  v_dot2c_f32_bf16 v58, v93, v7
  v_dot2c_f32_bf16 v59, v93, v8
  v_dot2c_f32_bf16 v60, v94, v7
  v_dot2c_f32_bf16 v61, v94, v8
  v_dot2c_f32_bf16 v62, v95, v7
  v_dot2c_f32_bf16 v63, v95, v8
  v_dot2c_f32_bf16 v64, v96, v7
  v_dot2c_f32_bf16 v65, v96, v8
  v_dot2c_f32_bf16 v66, v97, v7
  v_dot2c_f32_bf16 v67, v97, v8
  v_dot2c_f32_bf16 v68, v98, v7
  v_dot2c_f32_bf16 v69, v98, v8
  v_dot2c_f32_bf16 v70, v99, v7
  v_dot2c_f32_bf16 v71, v99, v8
  v_dot2c_f32_bf16 v72, v100, v7
  v_dot2c_f32_bf16 v73, v100, v8
  v_dot2c_f32_bf16 v74, v101, v7
  v_dot2c_f32_bf16 v75, v101, v8
  v_dot2c_f32_bf16 v76, v102, v7
  v_dot2c_f32_bf16 v77, v102, v8
  v_dot2c_f32_bf16 v78, v103, v7
  v_dot2c_f32_bf16 v79, v103, v8
  buffer_load_dwordx4 v[92:95], v1, s[32:35], s50 offen offset:0 nt
  buffer_load_dwordx4 v[96:99], v1, s[32:35], s50 offen offset:128 nt
  buffer_load_dwordx4 v[100:103], v1, s[32:35], s50 offen offset:256 nt
  s_mov_b32 s62, s50
  s_waitcnt lgkmcnt(0)
  v_readfirstlane_b32 s47, v14
  s_mov_b32 s96, 0
L_loop:
  s_cmp_eq_u32 s62, 2146435072
  s_cbranch_scc1 L_done
  s_cmp_lg_u32 s47, -1
  s_cbranch_scc1 L_tkw_done_63
  s_mov_b32 s46, 262144
L_tkw_62:
  ds_read_b32 v14, v13
  s_waitcnt lgkmcnt(0)
  v_readfirstlane_b32 s47, v14
  s_cmp_lg_u32 s47, -1
  s_cbranch_scc1 L_tkw_done_63
  s_sub_u32 s46, s46, 1
  s_cbranch_scc1 L_tkw_done_63
  s_sleep 1
  s_branch L_tkw_62
L_tkw_done_63:
  s_mul_i32 s50, s47, 3072
  s_add_u32 s50, s50, s41
  s_cmp_lt_u32 s47, 800
  s_cselect_b32 s50, s50, 2146435072
  s_waitcnt vmcnt(3)
  v_mov_b32 v4, 0
  v_mov_b32 v5, 0
  v_dot2c_f32_bf16 v4, v80, v44
  v_dot2c_f32_bf16 v5, v81, v45
  v_dot2c_f32_bf16 v4, v82, v46
  v_dot2c_f32_bf16 v5, v83, v47
  v_dot2c_f32_bf16 v4, v84, v48
  v_dot2c_f32_bf16 v5, v85, v49
  v_dot2c_f32_bf16 v4, v86, v50
  v_dot2c_f32_bf16 v5, v87, v51
  v_dot2c_f32_bf16 v4, v88, v52
  v_dot2c_f32_bf16 v5, v89, v53
  v_dot2c_f32_bf16 v4, v90, v54
  v_dot2c_f32_bf16 v5, v91, v55
  buffer_load_dwordx4 v[80:83], v1, s[28:31], s50 offen offset:0 nt
  buffer_load_dwordx4 v[84:87], v1, s[28:31], s50 offen offset:128 nt
  buffer_load_dwordx4 v[88:91], v1, s[28:31], s50 offen offset:256 nt
  v_add_f32 v4, v4, v5
  s_nop 1
  v_add_f32_dpp v4, v4, v4 quad_perm:[1,0,3,2] row_mask:0xf bank_mask:0xf
  s_nop 1
  v_add_f32_dpp v4, v4, v4 quad_perm:[2,3,0,1] row_mask:0xf bank_mask:0xf
  s_nop 1
  v_add_f32_dpp v4, v4, v4 row_half_mirror row_mask:0xf bank_mask:0xf
  v_cvt_pk_bf16_f32 v4, 0, v4
  v_mul_f32 v4, s54, v4
  v_cvt_pk_bf16_f32 v4, 0, v4
  s_mov_b64 exec, 1
  ds_add_rtn_u32 v13, v15, v16 offset:24
  s_mov_b64 exec, -1
  v_cmp_gt_f32 vcc, v4, v2
  s_cbranch_vccz L_nores_64
  v_max_f32 v5, v2, v4
  s_nop 1
  v_max_f32_dpp v5, v5, v5 row_ror:8 row_mask:0xf bank_mask:0xf
  v_mov_b32 v6, v5
  s_nop 1
  v_permlane16_swap_b32 v5, v6
  v_max_f32 v5, v5, v6
  v_mov_b32 v6, v5
  s_nop 1
  v_permlane32_swap_b32 v5, v6
  v_max_f32 v5, v5, v6
  v_sub_f32 v6, v2, v5
  v_mul_f32 v6, s55, v6
  v_exp_f32 v6, v6
  v_mov_b32 v2, v5
  v_mul_f32 v3, v3, v6
  v_mul_f32 v56, v56, v6
  v_mul_f32 v57, v57, v6
  v_mul_f32 v58, v58, v6
  v_mul_f32 v59, v59, v6
  v_mul_f32 v60, v60, v6
  v_mul_f32 v61, v61, v6
  v_mul_f32 v62, v62, v6
  v_mul_f32 v63, v63, v6
  v_mul_f32 v64, v64, v6
  v_mul_f32 v65, v65, v6
  v_mul_f32 v66, v66, v6
  v_mul_f32 v67, v67, v6
  v_mul_f32 v68, v68, v6
  v_mul_f32 v69, v69, v6
  v_mul_f32 v70, v70, v6
  v_mul_f32 v71, v71, v6
  v_mul_f32 v72, v72, v6
  v_mul_f32 v73, v73, v6
  v_mul_f32 v74, v74, v6
  v_mul_f32 v75, v75, v6
  v_mul_f32 v76, v76, v6
  v_mul_f32 v77, v77, v6
  v_mul_f32 v78, v78, v6
  v_mul_f32 v79, v79, v6
L_nores_64:
  v_sub_f32 v6, v4, v2
  v_mul_f32 v6, s55, v6
  v_exp_f32 v6, v6
  s_nop 0
  v_add_f32 v3, v3, v6
  v_cvt_pk_bf16_f32 v7, v6, 0
  v_cvt_pk_bf16_f32 v8, 0, v6
  s_waitcnt lgkmcnt(0)
  v_readfirstlane_b32 s44, v13
  s_lshl_b32 s44, s44, 2
  s_add_u32 s44, s44, 8256
  v_mov_b32 v13, s44
  ds_read_b32 v14, v13
  s_waitcnt vmcnt(3)
  v_dot2c_f32_bf16 v56, v92, v7
  v_dot2c_f32_bf16 v57, v92, v8
  v_dot2c_f32_bf16 v58, v93, v7
  v_dot2c_f32_bf16 v59, v93, v8
  v_dot2c_f32_bf16 v60, v94, v7
  v_dot2c_f32_bf16 v61, v94, v8
  v_dot2c_f32_bf16 v62, v95, v7
  v_dot2c_f32_bf16 v63, v95, v8
  v_dot2c_f32_bf16 v64, v96, v7
  v_dot2c_f32_bf16 v65, v96, v8
  v_dot2c_f32_bf16 v66, v97, v7
  v_dot2c_f32_bf16 v67, v97, v8
  v_dot2c_f32_bf16 v68, v98, v7
  v_dot2c_f32_bf16 v69, v98, v8
  v_dot2c_f32_bf16 v70, v99, v7
  v_dot2c_f32_bf16 v71, v99, v8
  v_dot2c_f32_bf16 v72, v100, v7
  v_dot2c_f32_bf16 v73, v100, v8
  v_dot2c_f32_bf16 v74, v101, v7
  v_dot2c_f32_bf16 v75, v101, v8
  v_dot2c_f32_bf16 v76, v102, v7
  v_dot2c_f32_bf16 v77, v102, v8
  v_dot2c_f32_bf16 v78, v103, v7
  v_dot2c_f32_bf16 v79, v103, v8
  buffer_load_dwordx4 v[92:95], v1, s[32:35], s50 offen offset:0 nt
  buffer_load_dwordx4 v[96:99], v1, s[32:35], s50 offen offset:128 nt
  buffer_load_dwordx4 v[100:103], v1, s[32:35], s50 offen offset:256 nt
  s_mov_b32 s62, s50
  s_waitcnt lgkmcnt(0)
  v_readfirstlane_b32 s47, v14
  s_add_u32 s96, s96, 1
  s_cmp_lt_u32 s96, 864
  s_cbranch_scc1 L_loop
L_done:
  v_mov_b32 v4, v2
  v_lshrrev_b32 v5, 3, v0
  v_and_b32 v10, 7, v0
  v_lshlrev_b32 v10, 5, v10
  v_lshl_add_u32 v10, v5, 2, v10
  s_sub_u32 s44, s3, 4
  s_mul_i32 s44, s44, 800
  v_add_u32 v10, s44, v10
  v_add_f32_dpp v3, v3, v3 row_ror:8 row_mask:0xf bank_mask:0xf
  v_permlane32_swap_b32 v56, v60
  v_permlane32_swap_b32 v57, v61
  v_permlane32_swap_b32 v58, v62
  v_permlane32_swap_b32 v59, v63
  v_permlane32_swap_b32 v64, v68
  v_permlane32_swap_b32 v65, v69
  v_permlane32_swap_b32 v66, v70
  v_permlane32_swap_b32 v67, v71
  v_permlane32_swap_b32 v72, v76
  v_permlane32_swap_b32 v73, v77
  v_permlane32_swap_b32 v74, v78
  v_permlane32_swap_b32 v75, v79
  v_add_f32 v56, v56, v60
  v_add_f32 v57, v57, v61
  v_add_f32 v58, v58, v62
  v_add_f32 v59, v59, v63
  v_add_f32 v64, v64, v68
  v_add_f32 v65, v65, v69
  v_add_f32 v66, v66, v70
  v_add_f32 v67, v67, v71
  v_add_f32 v72, v72, v76
  v_add_f32 v73, v73, v77
  v_add_f32 v74, v74, v78
  v_add_f32 v75, v75, v79
  v_permlane16_swap_b32 v56, v58
  v_permlane16_swap_b32 v57, v59
  v_permlane16_swap_b32 v64, v66
  v_permlane16_swap_b32 v65, v67
  v_permlane16_swap_b32 v72, v74
  v_permlane16_swap_b32 v73, v75
  v_add_f32 v56, v56, v58
  v_add_f32 v57, v57, v59
  v_add_f32 v64, v64, v66
  v_add_f32 v65, v65, v67
  v_add_f32 v72, v72, v74
  v_add_f32 v73, v73, v75
  v_add_f32_dpp v56, v56, v56 row_ror:8 row_mask:0xf bank_mask:0xf
  v_add_f32_dpp v57, v57, v57 row_ror:8 row_mask:0xf bank_mask:0xf
  v_add_f32_dpp v64, v64, v64 row_ror:8 row_mask:0xf bank_mask:0xf
  v_add_f32_dpp v65, v65, v65 row_ror:8 row_mask:0xf bank_mask:0xf
  v_add_f32_dpp v72, v72, v72 row_ror:8 row_mask:0xf bank_mask:0xf
  v_add_f32_dpp v73, v73, v73 row_ror:8 row_mask:0xf bank_mask:0xf
  v_cndmask_b32 v56, v56, v57, s[48:49]
  v_cndmask_b32 v64, v64, v65, s[48:49]
  v_cndmask_b32 v72, v72, v73, s[48:49]
  ds_write_b32 v10, v56 offset:0
  ds_write_b32 v10, v64 offset:256
  ds_write_b32 v10, v72 offset:512
  v_mov_b32 v5, v3
  s_nop 1
  v_permlane16_swap_b32 v3, v5
  v_add_f32 v3, v3, v5
  v_mov_b32 v5, v3
  s_nop 1
  v_permlane32_swap_b32 v3, v5
  v_add_f32 v3, v3, v5
  v_mov_b32 v5, s44
  s_mov_b64 exec, 1
  ds_write_b32 v5, v4 offset:768
  ds_write_b32 v5, v3 offset:772
  s_mov_b64 exec, -1
  s_waitcnt lgkmcnt(0)
  s_barrier
L_end:
  s_endpgm
.section .rodata,"a"
.p2align 6
.amdhsa_kernel parallel_sum__mha_block_cached__glu_gated_bilinear__decode_kernel
  .amdhsa_next_free_vgpr 256
  .amdhsa_next_free_sgpr 102
  .amdhsa_accum_offset 256
  .amdhsa_group_segment_fixed_size 0
  .amdhsa_kernarg_size 96
  .amdhsa_user_sgpr_count 2
  .amdhsa_user_sgpr_kernarg_segment_ptr 1
  .amdhsa_system_sgpr_workgroup_id_x 1
.end_amdhsa_kernel
```
